```python
import torch

def _softmax(x, axis=-1):
    return torch.softmax(x, dim=axis)
def _gelu(x):
    return torch.nn.functional.gelu(x, approximate="tanh")
def _silu(x):
    return torch.nn.functional.silu(x)
def _sigmoid(x):
    return torch.sigmoid(x)
def _layernorm(x, axis=-1, eps=1e-5):
    m = x.mean(dim=axis, keepdim=True)
    v = x.var(dim=axis, keepdim=True, unbiased=False)
    return (x - m) / torch.sqrt(v + eps)
def _scatter_add(tgt, idx, src, axis=0):
    return tgt.clone().index_add_(axis, idx, src)
def _segment_sum(src, seg, n):
    out = torch.zeros((n,) + src.shape[1:], dtype=src.dtype)
    return out.index_add_(0, seg, src)
def _pad(x, pw):
    flat = tuple(v for pair in reversed(pw) for v in pair)
    return torch.nn.functional.pad(x, flat)

kernel_name = 'recurrent_scan__softmax_full_mha__mixer_channel_mlp__prompt'

def setup_inputs():

    _w = (lambda a: (lambda t: t.to(torch.bfloat16) if t.is_floating_point() else t)(torch.as_tensor(a)))
    def _A_setup():
        B, S, D = 1, 2048, 640
        return {
            "x": _w((lambda *s: torch.randn(*s, dtype=torch.bfloat16) * 0.05)(B, S, D)),
            "wqkv": _w((lambda *s: torch.randn(*s, dtype=torch.bfloat16) * 0.05)(D, 3 * D)),
            "wo": _w((lambda *s: torch.randn(*s, dtype=torch.bfloat16) * 0.05)(D, D)),
        }
    _A_in = _A_setup()

    def _B_setup():
        B, S, D, F = 1, 2048, 640, 1728
        return {
            "x": _w((lambda *s: torch.randn(*s, dtype=torch.bfloat16) * 0.05)(B, S, D)),
            "w1": _w((lambda *s: torch.randn(*s, dtype=torch.bfloat16) * 3.2)(D, F) * (D ** -0.5)),
            "b1": _w((lambda *s: torch.randn(*s, dtype=torch.bfloat16) * 1.6)(F)),
            "w2": _w((lambda *s: torch.randn(*s, dtype=torch.bfloat16) * 0.05)(F, D) * (F ** -0.5)),
            "b2": _w((lambda *s: torch.randn(*s, dtype=torch.bfloat16) * 0.05)(D)),
        }
    _B_in = _B_setup()

    return {
        "A_x": _A_in["x"],
        "A_wqkv": _A_in["wqkv"],
        "A_wo": _A_in["wo"],
        "B_x": _B_in["x"],
        "B_w1": _B_in["w1"],
        "B_b1": _B_in["b1"],
        "B_w2": _B_in["w2"],
        "B_b2": _B_in["b2"],
    }

def reference(A_x, A_wqkv, A_wo, B_x, B_w1, B_b1, B_w2, B_b2):
    def _A_ref(x, wqkv, wo):
        B, S, D = x.shape
        H = 32; Dh = D // H
        qkv = (lambda x, *d: x.permute(*d))((x @ wqkv).reshape(B, S, 3, H, Dh), 2, 0, 3, 1, 4)
        q, k, v = qkv[0], qkv[1], qkv[2]
        scale = Dh ** -0.5
        scores = torch.einsum("bhqd,bhkd->bhqk", q, k) * scale
        p = _softmax(scores, axis=-1)
        o = torch.einsum("bhqk,bhkd->bhqd", p, v)
        return (lambda x, *d: x.permute(*d))(o, 0, 2, 1, 3).reshape(B, S, D) @ wo

    def _B_ref(x, w1, b1, w2, b2):
        y = _layernorm(x, axis=-1)
        h = _gelu(torch.einsum("bsd,df->bsf", y, w1) + b1)
        return torch.einsum("bsf,fd->bsd", h, w2) + b2

    x = A_x
    xn = _layernorm(x, axis=-1)
    s = _A_ref(xn, A_wqkv, A_wo)
    g = _silu(_B_ref(xn, B_w1, B_b1, B_w2, B_b2))
    return x + s * g
```

```asm
; @launch kernel=k1_kernel grid=(256,1,1) block=(512,1,1) lds=163840
; @launch kernel=k2_kernel grid=(256,1,1) block=(768,1,1) lds=163840
; @launch kernel=k3_kernel grid=(256,1,1) block=(640,1,1) lds=81920
.amdgcn_target "amdgcn-amd-amdhsa--gfx950"
.text
.globl k1_kernel
.p2align 8
.type k1_kernel,@function
k1_kernel:
    s_cmp_ge_u32 s2, 256
    s_cbranch_scc1 K1_END
    s_load_dwordx2 s[4:5], s[0:1], 0
    s_load_dwordx2 s[28:29], s[0:1], 8
    s_load_dwordx2 s[30:31], s[0:1], 32
    s_load_dwordx2 s[26:27], s[0:1], 40
    s_load_dwordx2 s[24:25], s[0:1], 80
    s_load_dwordx2 s[32:33], s[0:1], 48
    s_load_dwordx2 s[34:35], s[0:1], 16
    s_memrealtime s[6:7]
    s_mov_b32 s93, 0
    v_and_b32 v1, 63, v0
    v_lshrrev_b32 v2, 6, v0
    s_and_b32 s3, s2, 7
    s_lshr_b32 s52, s2, 3
    v_readfirstlane_b32 s38, v2
    s_and_b32 s36, s3, 1
    s_lshl_b32 s36, s36, 3
    s_and_b32 s60, s52, 7
    s_add_u32 s36, s36, s60
    s_lshr_b32 s37, s3, 1
    s_lshl_b32 s37, s37, 2
    s_lshr_b32 s61, s52, 3
    s_add_u32 s37, s37, s61
    s_and_b32 s39, s38, 1
    s_lshr_b32 s40, s38, 1
    s_lshl_b32 s41, s39, 1
    s_add_u32 s41, s41, s40
    s_and_b32 s41, s41, 3
    s_lshl_b32 s44, s37, 7
    s_cmp_ge_u32 s38, 4
    s_mov_b32 s43, 3840
    s_cselect_b32 s43, 3456, s43
    s_lshl_b32 s45, s38, 11
    s_add_u32 s45, s45, 98304
    s_lshl_b32 s46, s38, 12
    s_lshl_b32 s49, s43, 6
    s_lshl_b32 s50, s40, 5
    s_add_u32 s50, s50, s44
    s_mov_b32 s51, 0
    s_cmp_ge_u32 s50, 640
    s_cselect_b32 s51, 1, s51
    s_cmp_ge_u32 s50, 1280
    s_cselect_b32 s51, 2, s51
    s_mul_i32 s53, s51, 640
    s_sub_u32 s53, s50, s53
    s_cmp_lt_u32 s50, 1728
    s_cselect_b32 s54, 1, 0
    s_add_u32 s68, s36, s37
    s_cmp_ge_u32 s68, 20
    s_cselect_b32 s55, 20, 0
    s_sub_u32 s68, s68, s55
    s_cmp_ge_u32 s68, 10
    s_cselect_b32 s55, 10, 0
    s_sub_u32 s68, s68, s55
    s_mov_b32 s69, s68
    s_lshl_b32 s47, s68, 7
    s_mul_i32 s48, s68, s49
    s_lshl_b32 s55, s38, 4
    s_add_u32 s55, s55, 0
    v_lshrrev_b32 v2, 3, v1
    v_add_u32 v2, s55, v2
    v_lshrrev_b32 v3, 1, v2
    v_and_b32 v3, 7, v3
    v_and_b32 v4, 7, v1
    v_xor_b32 v3, v3, v4
    s_lshl_b32 s55, s36, 7
    v_add_u32 v2, s55, v2
    v_mul_u32_u24 v2, 1280, v2
    v_lshl_add_u32 v8, v3, 4, v2
    s_lshl_b32 s55, s38, 4
    s_add_u32 s55, s55, 8
    v_lshrrev_b32 v2, 3, v1
    v_add_u32 v2, s55, v2
    v_lshrrev_b32 v3, 1, v2
    v_and_b32 v3, 7, v3
    v_and_b32 v4, 7, v1
    v_xor_b32 v3, v3, v4
    s_lshl_b32 s55, s36, 7
    v_add_u32 v2, s55, v2
    v_mul_u32_u24 v2, 1280, v2
    v_lshl_add_u32 v9, v3, 4, v2
    s_and_b32 s55, s38, 3
    s_lshl_b32 s55, s55, 4
    s_add_u32 s55, s55, 0
    v_lshrrev_b32 v2, 4, v1
    v_add_u32 v2, s55, v2
    v_and_b32 v3, 3, v2
    v_and_b32 v4, 15, v1
    v_lshrrev_b32 v5, 2, v4
    v_xor_b32 v5, v5, v3
    v_and_b32 v4, 3, v4
    v_lshl_add_u32 v4, v5, 2, v4
    v_mul_lo_u32 v2, v2, s43
    v_lshl_add_u32 v2, v4, 4, v2
    s_lshl_b32 s55, s44, 1
    v_add_u32 v10, s55, v2
    s_and_b32 s55, s38, 3
    s_lshl_b32 s55, s55, 4
    s_add_u32 s55, s55, 4
    v_lshrrev_b32 v2, 4, v1
    v_add_u32 v2, s55, v2
    v_and_b32 v3, 3, v2
    v_and_b32 v4, 15, v1
    v_lshrrev_b32 v5, 2, v4
    v_xor_b32 v5, v5, v3
    v_and_b32 v4, 3, v4
    v_lshl_add_u32 v4, v5, 2, v4
    v_mul_lo_u32 v2, v2, s43
    v_lshl_add_u32 v2, v4, 4, v2
    s_lshl_b32 s55, s44, 1
    v_add_u32 v11, s55, v2
    s_and_b32 s55, s38, 3
    s_lshl_b32 s55, s55, 4
    s_add_u32 s55, s55, 8
    v_lshrrev_b32 v2, 4, v1
    v_add_u32 v2, s55, v2
    v_and_b32 v3, 3, v2
    v_and_b32 v4, 15, v1
    v_lshrrev_b32 v5, 2, v4
    v_xor_b32 v5, v5, v3
    v_and_b32 v4, 3, v4
    v_lshl_add_u32 v4, v5, 2, v4
    v_mul_lo_u32 v2, v2, s43
    v_lshl_add_u32 v2, v4, 4, v2
    s_lshl_b32 s55, s44, 1
    v_add_u32 v12, s55, v2
    s_and_b32 s55, s38, 3
    s_lshl_b32 s55, s55, 4
    s_add_u32 s55, s55, 12
    v_lshrrev_b32 v2, 4, v1
    v_add_u32 v2, s55, v2
    v_and_b32 v3, 3, v2
    v_and_b32 v4, 15, v1
    v_lshrrev_b32 v5, 2, v4
    v_xor_b32 v5, v5, v3
    v_and_b32 v4, 3, v4
    v_lshl_add_u32 v4, v5, 2, v4
    v_mul_lo_u32 v2, v2, s43
    v_lshl_add_u32 v2, v4, 4, v2
    s_lshl_b32 s55, s44, 1
    v_add_u32 v13, s55, v2
    s_waitcnt lgkmcnt(0)
    s_mov_b32 s16, s24
    s_mov_b32 s17, s25
    s_mov_b32 s18, 75497472
    s_mov_b32 s19, 0x00020000
    s_cmp_eq_u32 s37, 15
    s_cbranch_scc1 K1_TRANS
    s_mov_b32 s84, s4
    s_mov_b32 s85, s5
    s_mov_b32 s86, 2621440
    s_mov_b32 s87, 0x00020000
    s_cmp_ge_u32 s38, 4
    s_cselect_b32 s12, s30, s28
    s_cselect_b32 s13, s31, s29
    s_mov_b32 s14, 2457600
    s_cselect_b32 s14, 2211840, s14
    s_mov_b32 s15, 0x00020000
    s_add_u32 m0, s45, 0
    s_nop 0
    buffer_load_dwordx4 v8, s[84:87], s47 offen lds
    s_add_u32 m0, s45, 1024
    s_nop 0
    buffer_load_dwordx4 v9, s[84:87], s47 offen lds
    s_add_u32 m0, s46, 0
    s_nop 0
    buffer_load_dwordx4 v10, s[12:15], s48 offen lds
    s_add_u32 m0, s46, 1024
    s_nop 0
    buffer_load_dwordx4 v11, s[12:15], s48 offen lds
    s_add_u32 m0, s46, 2048
    s_nop 0
    buffer_load_dwordx4 v12, s[12:15], s48 offen lds
    s_add_u32 m0, s46, 3072
    s_nop 0
    buffer_load_dwordx4 v13, s[12:15], s48 offen lds
    s_add_u32 s47, s47, 128
    s_add_u32 s48, s48, s49
    s_add_u32 s69, s69, 1
    s_cmp_eq_u32 s69, 10
    s_cselect_b32 s47, 0, s47
    s_cselect_b32 s48, 0, s48
    s_cselect_b32 s69, 0, s69
    s_add_u32 m0, s45, 16384
    s_nop 0
    buffer_load_dwordx4 v8, s[84:87], s47 offen lds
    s_add_u32 m0, s45, 17408
    s_nop 0
    buffer_load_dwordx4 v9, s[84:87], s47 offen lds
    s_add_u32 m0, s46, 32768
    s_nop 0
    buffer_load_dwordx4 v10, s[12:15], s48 offen lds
    s_add_u32 m0, s46, 33792
    s_nop 0
    buffer_load_dwordx4 v11, s[12:15], s48 offen lds
    s_add_u32 m0, s46, 34816
    s_nop 0
    buffer_load_dwordx4 v12, s[12:15], s48 offen lds
    s_add_u32 m0, s46, 35840
    s_nop 0
    buffer_load_dwordx4 v13, s[12:15], s48 offen lds
    s_add_u32 s47, s47, 128
    s_add_u32 s48, s48, s49
    s_add_u32 s69, s69, 1
    s_cmp_eq_u32 s69, 10
    s_cselect_b32 s47, 0, s47
    s_cselect_b32 s48, 0, s48
    s_cselect_b32 s69, 0, s69
    s_mov_b32 s20, s26
    s_mov_b32 s21, s27
    s_mov_b32 s22, 3456
    s_mov_b32 s23, 0x00020000
    s_mov_b32 s8, s28
    s_mov_b32 s9, s29
    s_mov_b32 s10, 2457600
    s_mov_b32 s11, 0x00020000
    s_mov_b32 s80, s30
    s_mov_b32 s81, s31
    s_mov_b32 s82, 2211840
    s_mov_b32 s83, 0x00020000
    v_and_b32 v2, 31, v1
    v_lshrrev_b32 v3, 5, v1
    v_add_u32 v4, s50, v2
    v_lshlrev_b32 v4, 1, v4
    buffer_load_ushort v242, v4, s[20:23], 0 offen
    s_lshl_b32 s55, s39, 6
    v_add_u32 v5, s55, v2
    v_lshrrev_b32 v4, 1, v5
    v_and_b32 v4, 7, v4
    v_xor_b32 v4, v4, v3
    v_lshlrev_b32 v5, 7, v5
    v_lshl_add_u32 v5, v4, 4, v5
    v_add_u32 v5, 98304, v5
    s_add_u32 s55, s41, 0
    s_and_b32 s55, s55, 3
    s_lshl_b32 s55, s55, 5
    v_xor_b32 v14, s55, v5
    s_add_u32 s55, s41, 1
    s_and_b32 s55, s55, 3
    s_lshl_b32 s55, s55, 5
    v_xor_b32 v15, s55, v5
    s_add_u32 s55, s41, 2
    s_and_b32 s55, s55, 3
    s_lshl_b32 s55, s55, 5
    v_xor_b32 v16, s55, v5
    s_add_u32 s55, s41, 3
    s_and_b32 s55, s55, 3
    s_lshl_b32 s55, s55, 5
    v_xor_b32 v17, s55, v5
    v_and_b32 v7, 15, v1
    v_lshrrev_b32 v42, 2, v7
    v_and_b32 v4, 3, v7
    v_lshrrev_b32 v5, 4, v1
    v_and_b32 v6, 1, v5
    v_lshrrev_b32 v5, 1, v5
    v_lshl_add_u32 v5, v5, 3, v42
    v_lshlrev_b32 v5, 8, v5
    v_lshl_add_u32 v5, v6, 5, v5
    v_lshl_add_u32 v5, v4, 3, v5
    v_xor_b32 v6, s40, v42
    v_lshl_add_u32 v6, v6, 6, v5
    s_add_u32 s55, s41, 0
    s_and_b32 s55, s55, 3
    s_lshl_b32 s55, s55, 12
    v_add_u32 v18, s55, v6
    v_add_u32 v22, 0x10000, v18
    s_add_u32 s55, s41, 1
    s_and_b32 s55, s55, 3
    s_lshl_b32 s55, s55, 12
    v_add_u32 v19, s55, v6
    v_add_u32 v23, 0x10000, v19
    s_add_u32 s55, s41, 2
    s_and_b32 s55, s55, 3
    s_lshl_b32 s55, s55, 12
    v_add_u32 v20, s55, v6
    v_add_u32 v24, 0x10000, v20
    s_add_u32 s55, s41, 3
    s_and_b32 s55, s55, 3
    s_lshl_b32 s55, s55, 12
    v_add_u32 v21, s55, v6
    v_add_u32 v25, 0x10000, v21
    v_mov_b32 v172, 0
    v_mov_b32 v173, 0
    v_mov_b32 v174, 0
    v_mov_b32 v175, 0
    v_mov_b32 v176, 0
    v_mov_b32 v177, 0
    v_mov_b32 v178, 0
    v_mov_b32 v179, 0
    v_mov_b32 v180, 0
    v_mov_b32 v181, 0
    v_mov_b32 v182, 0
    v_mov_b32 v183, 0
    s_lshl_b32 s55, s39, 3
    s_add_u32 s55, s55, s40
    s_lshl_b32 s55, s55, 9
    s_add_u32 s55, s55, 147456
    v_lshl_add_u32 v34, v1, 3, s55
    s_lshl_b32 s55, s40, 1
    s_add_u32 s55, s55, s39
    s_lshl_b32 s55, s55, 8
    s_add_u32 s55, s55, 155648
    v_lshl_add_u32 v35, v1, 2, s55
    s_lshr_b32 s55, s38, 1
    s_lshl_b32 s55, s55, 11
    s_and_b32 s56, s38, 1
    s_lshl_b32 s56, s56, 7
    s_add_u32 s55, s55, s56
    s_add_u32 s55, s55, 147456
    v_lshl_add_u32 v36, v7, 3, s55
    s_lshl_b32 s55, s38, 9
    s_add_u32 s55, s55, 155648
    v_lshl_add_u32 v37, v2, 2, s55
    s_mul_i32 s55, s36, 10
    s_add_u32 s55, s55, s68
    s_lshl_b32 s55, s55, 7
    s_lshl_b32 s56, s38, 4
    s_add_u32 s55, s55, s56
    s_lshl_b32 s55, s55, 4
    s_add_u32 s55, s55, 37748736
    v_lshl_add_u32 v38, v7, 4, s55
    s_mul_i32 s55, s37, 10
    s_add_u32 s55, s55, s68
    s_lshl_b32 s55, s55, 8
    s_lshl_b32 s56, s38, 5
    s_add_u32 s55, s55, s56
    s_lshl_b32 s55, s55, 3
    s_add_u32 s55, s55, 39845888
    v_lshl_add_u32 v39, v2, 3, s55
    s_mul_i32 s55, s36, 1280
    s_lshl_b32 s56, s39, 6
    s_add_u32 s55, s55, s56
    s_lshl_b32 s55, s55, 4
    s_add_u32 s55, s55, 37748736
    v_mul_u32_u24 v4, 10240, v3
    v_lshl_add_u32 v4, v2, 4, v4
    v_add_u32 v40, s55, v4
    s_mul_i32 s55, s37, 2560
    s_lshl_b32 s56, s40, 5
    s_add_u32 s55, s55, s56
    s_lshl_b32 s55, s55, 3
    s_add_u32 s55, s55, 39845888
    v_mul_u32_u24 v4, 10240, v3
    v_lshl_add_u32 v4, v2, 3, v4
    v_add_u32 v41, s55, v4
    s_lshl_b32 s55, s38, 10
    s_add_u32 s55, s55, 147456
    v_lshl_add_u32 v42, v2, 2, s55
    v_lshl_add_u32 v43, v3, 4, s55
    s_sub_u32 s88, s6, 700
    s_mov_b32 s89, 4096
    s_mov_b32 s90, 8192
    s_mov_b32 s92, 0
    s_mov_b32 s77, 0
    s_mov_b32 s64, 986500301
    s_mov_b32 s65, 925353388
    s_mov_b32 s66, 1.0
    s_cmp_eq_u32 s51, 0
    s_cselect_b32 s66, 1051011932, s66
    v_mov_b32 v252, 0
    v_mov_b32 v253, 0
    v_mov_b32 v254, 0
    v_mov_b32 v255, 0
    s_mov_b32 s57, 81920
    s_cmp_eq_u32 s51, 2
    s_cbranch_scc1 K1_AV
    v_lshlrev_b32 v6, 2, v3
    v_add_u32 v6, s53, v6
    v_add_u32 v6, 0, v6
    v_mul_u32_u24 v7, 3277, v6
    v_lshrrev_b32 v7, 16, v7
    v_mul_u32_u24 v5, 20, v7
    v_sub_u32 v5, v6, v5
    v_mul_lo_u32 v7, v7, s57
    v_lshrrev_b32 v6, 3, v5
    v_lshlrev_b32 v6, 9, v6
    v_and_b32 v4, 7, v5
    v_lshl_add_u32 v6, v4, 1, v6
    v_lshl_add_u32 v6, v2, 4, v6
    v_lshlrev_b32 v4, 3, v2
    v_add_u32 v4, 1024, v4
    v_cmp_lt_u32 vcc, 15, v5
    s_nop 1
    v_cndmask_b32 v6, v6, v4, vcc
    v_add_u32 v252, v6, v7
    v_lshlrev_b32 v6, 2, v3
    v_add_u32 v6, s53, v6
    v_add_u32 v6, 8, v6
    v_mul_u32_u24 v7, 3277, v6
    v_lshrrev_b32 v7, 16, v7
    v_mul_u32_u24 v5, 20, v7
    v_sub_u32 v5, v6, v5
    v_mul_lo_u32 v7, v7, s57
    v_lshrrev_b32 v6, 3, v5
    v_lshlrev_b32 v6, 9, v6
    v_and_b32 v4, 7, v5
    v_lshl_add_u32 v6, v4, 1, v6
    v_lshl_add_u32 v6, v2, 4, v6
    v_lshlrev_b32 v4, 3, v2
    v_add_u32 v4, 1024, v4
    v_cmp_lt_u32 vcc, 15, v5
    s_nop 1
    v_cndmask_b32 v6, v6, v4, vcc
    v_add_u32 v253, v6, v7
    v_lshlrev_b32 v6, 2, v3
    v_add_u32 v6, s53, v6
    v_add_u32 v6, 16, v6
    v_mul_u32_u24 v7, 3277, v6
    v_lshrrev_b32 v7, 16, v7
    v_mul_u32_u24 v5, 20, v7
    v_sub_u32 v5, v6, v5
    v_mul_lo_u32 v7, v7, s57
    v_lshrrev_b32 v6, 3, v5
    v_lshlrev_b32 v6, 9, v6
    v_and_b32 v4, 7, v5
    v_lshl_add_u32 v6, v4, 1, v6
    v_lshl_add_u32 v6, v2, 4, v6
    v_lshlrev_b32 v4, 3, v2
    v_add_u32 v4, 1024, v4
    v_cmp_lt_u32 vcc, 15, v5
    s_nop 1
    v_cndmask_b32 v6, v6, v4, vcc
    v_add_u32 v254, v6, v7
    v_lshlrev_b32 v6, 2, v3
    v_add_u32 v6, s53, v6
    v_add_u32 v6, 24, v6
    v_mul_u32_u24 v7, 3277, v6
    v_lshrrev_b32 v7, 16, v7
    v_mul_u32_u24 v5, 20, v7
    v_sub_u32 v5, v6, v5
    v_mul_lo_u32 v7, v7, s57
    v_lshrrev_b32 v6, 3, v5
    v_lshlrev_b32 v6, 9, v6
    v_and_b32 v4, 7, v5
    v_lshl_add_u32 v6, v4, 1, v6
    v_lshl_add_u32 v6, v2, 4, v6
    v_lshlrev_b32 v4, 3, v2
    v_add_u32 v4, 1024, v4
    v_cmp_lt_u32 vcc, 15, v5
    s_nop 1
    v_cndmask_b32 v6, v6, v4, vcc
    v_add_u32 v255, v6, v7
    s_branch K1_ADONE
K1_AV:
    v_add_u32 v6, s53, v2
    v_mul_u32_u24 v7, 3277, v6
    v_lshrrev_b32 v7, 16, v7
    v_mul_u32_u24 v5, 20, v7
    v_sub_u32 v5, v6, v5
    v_mul_lo_u32 v7, v7, s57
    v_mul_u32_u24 v6, 320, v3
    v_lshl_add_u32 v6, v5, 4, v6
    v_add_u32 v252, v6, v7
K1_ADONE:
    s_cmp_eq_u32 s51, 2
    s_cbranch_scc1 K1_LOOPV
    s_waitcnt vmcnt(7)
    s_barrier
    ds_read_b128 v[44:47], v14 offset:0
    ds_read_b128 v[48:51], v14 offset:4096
    ds_read_b64_tr_b16 v[52:53], v18 offset:0
    ds_read_b64_tr_b16 v[54:55], v18 offset:1024
    ds_read_b64_tr_b16 v[56:57], v18 offset:16384
    ds_read_b64_tr_b16 v[58:59], v18 offset:17408
    ds_read_b128 v[60:63], v15 offset:0
    ds_read_b128 v[64:67], v15 offset:4096
    ds_read_b64_tr_b16 v[68:69], v19 offset:0
    ds_read_b64_tr_b16 v[70:71], v19 offset:1024
    ds_read_b64_tr_b16 v[72:73], v19 offset:16384
    ds_read_b64_tr_b16 v[74:75], v19 offset:17408
    s_waitcnt lgkmcnt(6)
    v_mfma_f32_32x32x16_bf16 v[108:123], v[52:55], v[44:47], 0
    v_lshlrev_b32 v200, 16, v44
    v_and_b32 v201, 0xffff0000, v44
    v_add_f32 v172, v172, v200
    v_add_f32 v173, v173, v201
    v_fmac_f32 v176, v200, v200
    v_fmac_f32 v177, v201, v201
    v_lshlrev_b32 v202, 16, v45
    v_and_b32 v203, 0xffff0000, v45
    v_add_f32 v172, v172, v202
    v_add_f32 v173, v173, v203
    v_fmac_f32 v176, v202, v202
    v_fmac_f32 v177, v203, v203
    v_lshlrev_b32 v204, 16, v46
    v_and_b32 v205, 0xffff0000, v46
    v_add_f32 v172, v172, v204
    v_add_f32 v173, v173, v205
    v_fmac_f32 v176, v204, v204
    v_fmac_f32 v177, v205, v205
    v_lshlrev_b32 v206, 16, v47
    v_and_b32 v207, 0xffff0000, v47
    s_add_u32 m0, s45, 32768
    s_nop 0
    buffer_load_dwordx4 v8, s[84:87], s47 offen lds
    v_mfma_f32_32x32x16_bf16 v[124:139], v[52:55], v[48:51], 0
    v_add_f32 v172, v172, v206
    v_add_f32 v173, v173, v207
    v_fmac_f32 v176, v206, v206
    v_fmac_f32 v177, v207, v207
    v_lshlrev_b32 v200, 16, v48
    v_and_b32 v201, 0xffff0000, v48
    v_add_f32 v174, v174, v200
    v_add_f32 v175, v175, v201
    v_fmac_f32 v178, v200, v200
    v_fmac_f32 v179, v201, v201
    v_lshlrev_b32 v202, 16, v49
    v_and_b32 v203, 0xffff0000, v49
    v_add_f32 v174, v174, v202
    v_add_f32 v175, v175, v203
    v_fmac_f32 v178, v202, v202
    v_fmac_f32 v179, v203, v203
    v_lshlrev_b32 v204, 16, v50
    v_and_b32 v205, 0xffff0000, v50
    v_add_f32 v174, v174, v204
    v_add_f32 v175, v175, v205
    v_mfma_f32_32x32x16_bf16 v[140:155], v[56:59], v[44:47], 0
    v_fmac_f32 v178, v204, v204
    v_fmac_f32 v179, v205, v205
    v_lshlrev_b32 v206, 16, v51
    v_and_b32 v207, 0xffff0000, v51
    v_add_f32 v174, v174, v206
    v_add_f32 v175, v175, v207
    v_fmac_f32 v178, v206, v206
    v_fmac_f32 v179, v207, v207
    v_lshlrev_b32 v200, 16, v52
    v_and_b32 v201, 0xffff0000, v52
    v_add_f32 v180, v180, v200
    v_add_f32 v181, v181, v201
    v_lshlrev_b32 v202, 16, v53
    v_and_b32 v203, 0xffff0000, v53
    v_add_f32 v180, v180, v202
    v_add_f32 v181, v181, v203
    v_lshlrev_b32 v204, 16, v54
    v_and_b32 v205, 0xffff0000, v54
    v_add_f32 v180, v180, v204
    v_add_f32 v181, v181, v205
    s_add_u32 m0, s45, 33792
    s_nop 0
    buffer_load_dwordx4 v9, s[84:87], s47 offen lds
    v_mfma_f32_32x32x16_bf16 v[156:171], v[56:59], v[48:51], 0
    v_lshlrev_b32 v206, 16, v55
    v_and_b32 v207, 0xffff0000, v55
    v_add_f32 v180, v180, v206
    v_add_f32 v181, v181, v207
    v_lshlrev_b32 v200, 16, v56
    v_and_b32 v201, 0xffff0000, v56
    v_add_f32 v182, v182, v200
    v_add_f32 v183, v183, v201
    v_lshlrev_b32 v202, 16, v57
    v_and_b32 v203, 0xffff0000, v57
    v_add_f32 v182, v182, v202
    v_add_f32 v183, v183, v203
    v_lshlrev_b32 v204, 16, v58
    v_and_b32 v205, 0xffff0000, v58
    v_add_f32 v182, v182, v204
    v_add_f32 v183, v183, v205
    v_lshlrev_b32 v206, 16, v59
    v_and_b32 v207, 0xffff0000, v59
    v_add_f32 v182, v182, v206
    v_add_f32 v183, v183, v207
    ds_read_b128 v[44:47], v16 offset:0
    ds_read_b128 v[48:51], v16 offset:4096
    ds_read_b64_tr_b16 v[52:53], v20 offset:0
    ds_read_b64_tr_b16 v[54:55], v20 offset:1024
    ds_read_b64_tr_b16 v[56:57], v20 offset:16384
    ds_read_b64_tr_b16 v[58:59], v20 offset:17408
    s_waitcnt lgkmcnt(6)
    v_mfma_f32_32x32x16_bf16 v[108:123], v[68:71], v[60:63], v[108:123]
    v_lshlrev_b32 v200, 16, v68
    v_and_b32 v201, 0xffff0000, v68
    v_add_f32 v180, v180, v200
    v_add_f32 v181, v181, v201
    v_lshlrev_b32 v202, 16, v69
    v_and_b32 v203, 0xffff0000, v69
    v_add_f32 v180, v180, v202
    v_add_f32 v181, v181, v203
    s_add_u32 m0, s46, 65536
    s_nop 0
    buffer_load_dwordx4 v10, s[12:15], s48 offen lds
    v_mfma_f32_32x32x16_bf16 v[124:139], v[68:71], v[64:67], v[124:139]
    v_lshlrev_b32 v204, 16, v70
    v_and_b32 v205, 0xffff0000, v70
    v_add_f32 v180, v180, v204
    v_add_f32 v181, v181, v205
    v_lshlrev_b32 v206, 16, v71
    v_and_b32 v207, 0xffff0000, v71
    v_add_f32 v180, v180, v206
    v_add_f32 v181, v181, v207
    v_mfma_f32_32x32x16_bf16 v[140:155], v[72:75], v[60:63], v[140:155]
    v_lshlrev_b32 v200, 16, v72
    v_and_b32 v201, 0xffff0000, v72
    v_add_f32 v182, v182, v200
    v_add_f32 v183, v183, v201
    v_lshlrev_b32 v202, 16, v73
    v_and_b32 v203, 0xffff0000, v73
    v_add_f32 v182, v182, v202
    v_add_f32 v183, v183, v203
    s_add_u32 m0, s46, 66560
    s_nop 0
    buffer_load_dwordx4 v11, s[12:15], s48 offen lds
    v_mfma_f32_32x32x16_bf16 v[156:171], v[72:75], v[64:67], v[156:171]
    v_lshlrev_b32 v204, 16, v74
    v_and_b32 v205, 0xffff0000, v74
    v_add_f32 v182, v182, v204
    v_add_f32 v183, v183, v205
    v_lshlrev_b32 v206, 16, v75
    v_and_b32 v207, 0xffff0000, v75
    v_add_f32 v182, v182, v206
    v_add_f32 v183, v183, v207
    s_waitcnt vmcnt(5)
    s_barrier
    ds_read_b128 v[60:63], v17 offset:0
    ds_read_b128 v[64:67], v17 offset:4096
    ds_read_b64_tr_b16 v[68:69], v21 offset:0
    ds_read_b64_tr_b16 v[70:71], v21 offset:1024
    ds_read_b64_tr_b16 v[72:73], v21 offset:16384
    ds_read_b64_tr_b16 v[74:75], v21 offset:17408
    s_waitcnt lgkmcnt(6)
    v_mfma_f32_32x32x16_bf16 v[108:123], v[52:55], v[44:47], v[108:123]
    v_add_f32 v200, v172, v173
    v_add_f32 v201, v176, v177
    v_add_f32 v202, v174, v175
    s_add_u32 m0, s46, 67584
    s_nop 0
    buffer_load_dwordx4 v12, s[12:15], s48 offen lds
    v_mfma_f32_32x32x16_bf16 v[124:139], v[52:55], v[48:51], v[124:139]
    v_add_f32 v203, v178, v179
    v_add_f32 v204, v180, v181
    v_add_f32 v205, v182, v183
    s_add_u32 m0, s46, 68608
    s_nop 0
    buffer_load_dwordx4 v13, s[12:15], s48 offen lds
    s_add_u32 s47, s47, 128
    s_add_u32 s48, s48, s49
    s_add_u32 s69, s69, 1
    s_cmp_eq_u32 s69, 10
    s_cselect_b32 s47, 0, s47
    s_cselect_b32 s48, 0, s48
    s_cselect_b32 s69, 0, s69
    v_mfma_f32_32x32x16_bf16 v[140:155], v[56:59], v[44:47], v[140:155]
    ds_write_b64 v34, v[200:201]
    ds_write_b64 v34, v[202:203] offset:2048
    ds_write_b32 v35, v204
    v_mfma_f32_32x32x16_bf16 v[156:171], v[56:59], v[48:51], v[156:171]
    ds_write_b32 v35, v205 offset:2048
    ds_read_b128 v[44:47], v14 offset:16384
    ds_read_b128 v[48:51], v14 offset:20480
    ds_read_b64_tr_b16 v[52:53], v18 offset:32768
    ds_read_b64_tr_b16 v[54:55], v18 offset:33792
    ds_read_b64_tr_b16 v[56:57], v18 offset:49152
    ds_read_b64_tr_b16 v[58:59], v18 offset:50176
    s_waitcnt lgkmcnt(6)
    v_mfma_f32_32x32x16_bf16 v[108:123], v[68:71], v[60:63], v[108:123]
    v_mfma_f32_32x32x16_bf16 v[124:139], v[68:71], v[64:67], v[124:139]
    v_mfma_f32_32x32x16_bf16 v[140:155], v[72:75], v[60:63], v[140:155]
    v_mfma_f32_32x32x16_bf16 v[156:171], v[72:75], v[64:67], v[156:171]
    s_barrier
    ds_read_b64 v[208:209], v36 offset:0
    ds_read_b64 v[210:211], v36 offset:256
    ds_read_b64 v[212:213], v36 offset:512
    ds_read_b64 v[214:215], v36 offset:768
    ds_read_b64 v[216:217], v36 offset:1024
    ds_read_b64 v[218:219], v36 offset:1280
    ds_read_b64 v[220:221], v36 offset:1536
    ds_read_b64 v[222:223], v36 offset:1792
    ds_read_b32 v224, v37 offset:0
    ds_read_b32 v225, v37 offset:128
    ds_read_b32 v226, v37 offset:256
    ds_read_b32 v227, v37 offset:384
    ds_read_b128 v[60:63], v15 offset:16384
    ds_read_b128 v[64:67], v15 offset:20480
    ds_read_b64_tr_b16 v[68:69], v19 offset:32768
    ds_read_b64_tr_b16 v[70:71], v19 offset:33792
    ds_read_b64_tr_b16 v[72:73], v19 offset:49152
    ds_read_b64_tr_b16 v[74:75], v19 offset:50176
    s_waitcnt lgkmcnt(6)
    v_mfma_f32_32x32x16_bf16 v[108:123], v[52:55], v[44:47], v[108:123]
    s_add_u32 m0, s45, 0
    s_nop 0
    buffer_load_dwordx4 v8, s[84:87], s47 offen lds
    v_mfma_f32_32x32x16_bf16 v[124:139], v[52:55], v[48:51], v[124:139]
    v_mfma_f32_32x32x16_bf16 v[140:155], v[56:59], v[44:47], v[140:155]
    s_add_u32 m0, s45, 1024
    s_nop 0
    buffer_load_dwordx4 v9, s[84:87], s47 offen lds
    v_mfma_f32_32x32x16_bf16 v[156:171], v[56:59], v[48:51], v[156:171]
    ds_read_b128 v[44:47], v16 offset:16384
    ds_read_b128 v[48:51], v16 offset:20480
    ds_read_b64_tr_b16 v[52:53], v20 offset:32768
    ds_read_b64_tr_b16 v[54:55], v20 offset:33792
    ds_read_b64_tr_b16 v[56:57], v20 offset:49152
    ds_read_b64_tr_b16 v[58:59], v20 offset:50176
    s_waitcnt lgkmcnt(6)
    v_mfma_f32_32x32x16_bf16 v[108:123], v[68:71], v[60:63], v[108:123]
    v_add_f32 v208, v208, v210
    v_add_f32 v209, v209, v211
    v_add_f32 v208, v208, v212
    v_add_f32 v209, v209, v213
    v_add_f32 v208, v208, v214
    s_add_u32 m0, s46, 0
    s_nop 0
    buffer_load_dwordx4 v10, s[12:15], s48 offen lds
    v_mfma_f32_32x32x16_bf16 v[124:139], v[68:71], v[64:67], v[124:139]
    v_add_f32 v209, v209, v215
    v_add_f32 v208, v208, v216
    v_add_f32 v209, v209, v217
    v_add_f32 v208, v208, v218
    v_add_f32 v209, v209, v219
    v_mfma_f32_32x32x16_bf16 v[140:155], v[72:75], v[60:63], v[140:155]
    v_add_f32 v208, v208, v220
    v_add_f32 v209, v209, v221
    v_add_f32 v208, v208, v222
    v_add_f32 v209, v209, v223
    v_add_f32 v224, v224, v225
    s_add_u32 m0, s46, 1024
    s_nop 0
    buffer_load_dwordx4 v11, s[12:15], s48 offen lds
    v_mfma_f32_32x32x16_bf16 v[156:171], v[72:75], v[64:67], v[156:171]
    v_add_f32 v226, v226, v227
    v_add_f32 v224, v224, v226
    s_waitcnt vmcnt(4)
    s_barrier
    ds_read_b128 v[60:63], v17 offset:16384
    ds_read_b128 v[64:67], v17 offset:20480
    ds_read_b64_tr_b16 v[68:69], v21 offset:32768
    ds_read_b64_tr_b16 v[70:71], v21 offset:33792
    ds_read_b64_tr_b16 v[72:73], v21 offset:49152
    ds_read_b64_tr_b16 v[74:75], v21 offset:50176
    s_waitcnt lgkmcnt(6)
    v_mfma_f32_32x32x16_bf16 v[108:123], v[52:55], v[44:47], v[108:123]
    s_add_u32 m0, s46, 2048
    s_nop 0
    buffer_load_dwordx4 v12, s[12:15], s48 offen lds
    v_mfma_f32_32x32x16_bf16 v[124:139], v[52:55], v[48:51], v[124:139]
    s_add_u32 m0, s46, 3072
    s_nop 0
    buffer_load_dwordx4 v13, s[12:15], s48 offen lds
    s_add_u32 s47, s47, 128
    s_add_u32 s48, s48, s49
    s_add_u32 s69, s69, 1
    s_cmp_eq_u32 s69, 10
    s_cselect_b32 s47, 0, s47
    s_cselect_b32 s48, 0, s48
    s_cselect_b32 s69, 0, s69
    v_mfma_f32_32x32x16_bf16 v[140:155], v[56:59], v[44:47], v[140:155]
    v_mfma_f32_32x32x16_bf16 v[156:171], v[56:59], v[48:51], v[156:171]
    ds_read_b128 v[44:47], v14 offset:32768
    ds_read_b128 v[48:51], v14 offset:36864
    ds_read_b64_tr_b16 v[52:53], v22 offset:0
    ds_read_b64_tr_b16 v[54:55], v22 offset:1024
    ds_read_b64_tr_b16 v[56:57], v22 offset:16384
    ds_read_b64_tr_b16 v[58:59], v22 offset:17408
    s_waitcnt lgkmcnt(6)
    v_mfma_f32_32x32x16_bf16 v[108:123], v[68:71], v[60:63], v[108:123]
    v_mfma_f32_32x32x16_bf16 v[124:139], v[68:71], v[64:67], v[124:139]
    v_mfma_f32_32x32x16_bf16 v[140:155], v[72:75], v[60:63], v[140:155]
    v_mfma_f32_32x32x16_bf16 v[156:171], v[72:75], v[64:67], v[156:171]
    v_mov_b32 v210, s6
    v_mov_b32 v211, 0
    v_mov_b32 v225, s6
    buffer_store_dwordx4 v[208:211], v38, s[16:19], 0 offen sc0 sc1
    buffer_store_dwordx2 v[224:225], v39, s[16:19], 0 offen sc0 sc1
    s_barrier
    ds_read_b128 v[60:63], v15 offset:32768
    ds_read_b128 v[64:67], v15 offset:36864
    ds_read_b64_tr_b16 v[68:69], v23 offset:0
    ds_read_b64_tr_b16 v[70:71], v23 offset:1024
    ds_read_b64_tr_b16 v[72:73], v23 offset:16384
    ds_read_b64_tr_b16 v[74:75], v23 offset:17408
    s_waitcnt lgkmcnt(6)
    v_mfma_f32_32x32x16_bf16 v[108:123], v[52:55], v[44:47], v[108:123]
    s_add_u32 m0, s45, 16384
    s_nop 0
    buffer_load_dwordx4 v8, s[84:87], s47 offen lds
    v_mfma_f32_32x32x16_bf16 v[124:139], v[52:55], v[48:51], v[124:139]
    v_mfma_f32_32x32x16_bf16 v[140:155], v[56:59], v[44:47], v[140:155]
    s_add_u32 m0, s45, 17408
    s_nop 0
    buffer_load_dwordx4 v9, s[84:87], s47 offen lds
    v_mfma_f32_32x32x16_bf16 v[156:171], v[56:59], v[48:51], v[156:171]
    ds_read_b128 v[44:47], v16 offset:32768
    ds_read_b128 v[48:51], v16 offset:36864
    ds_read_b64_tr_b16 v[52:53], v24 offset:0
    ds_read_b64_tr_b16 v[54:55], v24 offset:1024
    ds_read_b64_tr_b16 v[56:57], v24 offset:16384
    ds_read_b64_tr_b16 v[58:59], v24 offset:17408
    s_waitcnt lgkmcnt(6)
    v_mfma_f32_32x32x16_bf16 v[108:123], v[68:71], v[60:63], v[108:123]
    s_add_u32 m0, s46, 32768
    s_nop 0
    buffer_load_dwordx4 v10, s[12:15], s48 offen lds
    v_mfma_f32_32x32x16_bf16 v[124:139], v[68:71], v[64:67], v[124:139]
    v_mfma_f32_32x32x16_bf16 v[140:155], v[72:75], v[60:63], v[140:155]
    s_add_u32 m0, s46, 33792
    s_nop 0
    buffer_load_dwordx4 v11, s[12:15], s48 offen lds
    v_mfma_f32_32x32x16_bf16 v[156:171], v[72:75], v[64:67], v[156:171]
    s_waitcnt vmcnt(6)
    s_barrier
    ds_read_b128 v[60:63], v17 offset:32768
    ds_read_b128 v[64:67], v17 offset:36864
    ds_read_b64_tr_b16 v[68:69], v25 offset:0
    ds_read_b64_tr_b16 v[70:71], v25 offset:1024
    ds_read_b64_tr_b16 v[72:73], v25 offset:16384
    ds_read_b64_tr_b16 v[74:75], v25 offset:17408
    s_waitcnt lgkmcnt(6)
    v_mfma_f32_32x32x16_bf16 v[108:123], v[52:55], v[44:47], v[108:123]
    s_add_u32 m0, s46, 34816
    s_nop 0
    buffer_load_dwordx4 v12, s[12:15], s48 offen lds
    v_mfma_f32_32x32x16_bf16 v[124:139], v[52:55], v[48:51], v[124:139]
    s_add_u32 m0, s46, 35840
    s_nop 0
    buffer_load_dwordx4 v13, s[12:15], s48 offen lds
    s_add_u32 s47, s47, 128
    s_add_u32 s48, s48, s49
    s_add_u32 s69, s69, 1
    s_cmp_eq_u32 s69, 10
    s_cselect_b32 s47, 0, s47
    s_cselect_b32 s48, 0, s48
    s_cselect_b32 s69, 0, s69
    v_mfma_f32_32x32x16_bf16 v[140:155], v[56:59], v[44:47], v[140:155]
    v_mfma_f32_32x32x16_bf16 v[156:171], v[56:59], v[48:51], v[156:171]
    ds_read_b128 v[44:47], v14 offset:0
    ds_read_b128 v[48:51], v14 offset:4096
    ds_read_b64_tr_b16 v[52:53], v18 offset:0
    ds_read_b64_tr_b16 v[54:55], v18 offset:1024
    ds_read_b64_tr_b16 v[56:57], v18 offset:16384
    ds_read_b64_tr_b16 v[58:59], v18 offset:17408
    s_waitcnt lgkmcnt(6)
    v_mfma_f32_32x32x16_bf16 v[108:123], v[68:71], v[60:63], v[108:123]
    v_mfma_f32_32x32x16_bf16 v[124:139], v[68:71], v[64:67], v[124:139]
    v_mfma_f32_32x32x16_bf16 v[140:155], v[72:75], v[60:63], v[140:155]
    v_mfma_f32_32x32x16_bf16 v[156:171], v[72:75], v[64:67], v[156:171]
    s_barrier
    ds_read_b128 v[60:63], v15 offset:0
    ds_read_b128 v[64:67], v15 offset:4096
    ds_read_b64_tr_b16 v[68:69], v19 offset:0
    ds_read_b64_tr_b16 v[70:71], v19 offset:1024
    ds_read_b64_tr_b16 v[72:73], v19 offset:16384
    ds_read_b64_tr_b16 v[74:75], v19 offset:17408
    s_waitcnt lgkmcnt(6)
    v_mfma_f32_32x32x16_bf16 v[108:123], v[52:55], v[44:47], v[108:123]
    s_add_u32 m0, s45, 32768
    s_nop 0
    buffer_load_dwordx4 v8, s[84:87], s47 offen lds
    v_mfma_f32_32x32x16_bf16 v[124:139], v[52:55], v[48:51], v[124:139]
    v_mfma_f32_32x32x16_bf16 v[140:155], v[56:59], v[44:47], v[140:155]
    s_add_u32 m0, s45, 33792
    s_nop 0
    buffer_load_dwordx4 v9, s[84:87], s47 offen lds
    v_mfma_f32_32x32x16_bf16 v[156:171], v[56:59], v[48:51], v[156:171]
    ds_read_b128 v[44:47], v16 offset:0
    ds_read_b128 v[48:51], v16 offset:4096
    ds_read_b64_tr_b16 v[52:53], v20 offset:0
    ds_read_b64_tr_b16 v[54:55], v20 offset:1024
    ds_read_b64_tr_b16 v[56:57], v20 offset:16384
    ds_read_b64_tr_b16 v[58:59], v20 offset:17408
    s_waitcnt lgkmcnt(6)
    v_mfma_f32_32x32x16_bf16 v[108:123], v[68:71], v[60:63], v[108:123]
    s_add_u32 m0, s46, 65536
    s_nop 0
    buffer_load_dwordx4 v10, s[12:15], s48 offen lds
    v_mfma_f32_32x32x16_bf16 v[124:139], v[68:71], v[64:67], v[124:139]
    v_mfma_f32_32x32x16_bf16 v[140:155], v[72:75], v[60:63], v[140:155]
    s_add_u32 m0, s46, 66560
    s_nop 0
    buffer_load_dwordx4 v11, s[12:15], s48 offen lds
    v_mfma_f32_32x32x16_bf16 v[156:171], v[72:75], v[64:67], v[156:171]
    s_waitcnt vmcnt(4)
    s_barrier
    ds_read_b128 v[60:63], v17 offset:0
    ds_read_b128 v[64:67], v17 offset:4096
    ds_read_b64_tr_b16 v[68:69], v21 offset:0
    ds_read_b64_tr_b16 v[70:71], v21 offset:1024
    ds_read_b64_tr_b16 v[72:73], v21 offset:16384
    ds_read_b64_tr_b16 v[74:75], v21 offset:17408
    s_waitcnt lgkmcnt(6)
    v_mfma_f32_32x32x16_bf16 v[108:123], v[52:55], v[44:47], v[108:123]
    s_add_u32 m0, s46, 67584
    s_nop 0
    buffer_load_dwordx4 v12, s[12:15], s48 offen lds
    v_mfma_f32_32x32x16_bf16 v[124:139], v[52:55], v[48:51], v[124:139]
    s_add_u32 m0, s46, 68608
    s_nop 0
    buffer_load_dwordx4 v13, s[12:15], s48 offen lds
    s_add_u32 s47, s47, 128
    s_add_u32 s48, s48, s49
    s_add_u32 s69, s69, 1
    s_cmp_eq_u32 s69, 10
    s_cselect_b32 s47, 0, s47
    s_cselect_b32 s48, 0, s48
    s_cselect_b32 s69, 0, s69
    v_mfma_f32_32x32x16_bf16 v[140:155], v[56:59], v[44:47], v[140:155]
    v_mfma_f32_32x32x16_bf16 v[156:171], v[56:59], v[48:51], v[156:171]
    ds_read_b128 v[44:47], v14 offset:16384
    ds_read_b128 v[48:51], v14 offset:20480
    ds_read_b64_tr_b16 v[52:53], v18 offset:32768
    ds_read_b64_tr_b16 v[54:55], v18 offset:33792
    ds_read_b64_tr_b16 v[56:57], v18 offset:49152
    ds_read_b64_tr_b16 v[58:59], v18 offset:50176
    s_waitcnt lgkmcnt(6)
    v_mfma_f32_32x32x16_bf16 v[108:123], v[68:71], v[60:63], v[108:123]
    v_mfma_f32_32x32x16_bf16 v[124:139], v[68:71], v[64:67], v[124:139]
    v_mfma_f32_32x32x16_bf16 v[140:155], v[72:75], v[60:63], v[140:155]
    v_mfma_f32_32x32x16_bf16 v[156:171], v[72:75], v[64:67], v[156:171]
    s_barrier
    ds_read_b128 v[60:63], v15 offset:16384
    ds_read_b128 v[64:67], v15 offset:20480
    ds_read_b64_tr_b16 v[68:69], v19 offset:32768
    ds_read_b64_tr_b16 v[70:71], v19 offset:33792
    ds_read_b64_tr_b16 v[72:73], v19 offset:49152
    ds_read_b64_tr_b16 v[74:75], v19 offset:50176
    s_waitcnt lgkmcnt(6)
    v_mfma_f32_32x32x16_bf16 v[108:123], v[52:55], v[44:47], v[108:123]
    s_add_u32 m0, s45, 0
    s_nop 0
    buffer_load_dwordx4 v8, s[84:87], s47 offen lds
    v_mfma_f32_32x32x16_bf16 v[124:139], v[52:55], v[48:51], v[124:139]
    v_mfma_f32_32x32x16_bf16 v[140:155], v[56:59], v[44:47], v[140:155]
    s_add_u32 m0, s45, 1024
    s_nop 0
    buffer_load_dwordx4 v9, s[84:87], s47 offen lds
    v_mfma_f32_32x32x16_bf16 v[156:171], v[56:59], v[48:51], v[156:171]
    ds_read_b128 v[44:47], v16 offset:16384
    ds_read_b128 v[48:51], v16 offset:20480
    ds_read_b64_tr_b16 v[52:53], v20 offset:32768
    ds_read_b64_tr_b16 v[54:55], v20 offset:33792
    ds_read_b64_tr_b16 v[56:57], v20 offset:49152
    ds_read_b64_tr_b16 v[58:59], v20 offset:50176
    s_waitcnt lgkmcnt(6)
    v_mfma_f32_32x32x16_bf16 v[108:123], v[68:71], v[60:63], v[108:123]
    s_add_u32 m0, s46, 0
    s_nop 0
    buffer_load_dwordx4 v10, s[12:15], s48 offen lds
    v_mfma_f32_32x32x16_bf16 v[124:139], v[68:71], v[64:67], v[124:139]
    v_mfma_f32_32x32x16_bf16 v[140:155], v[72:75], v[60:63], v[140:155]
    s_add_u32 m0, s46, 1024
    s_nop 0
    buffer_load_dwordx4 v11, s[12:15], s48 offen lds
    v_mfma_f32_32x32x16_bf16 v[156:171], v[72:75], v[64:67], v[156:171]
    s_waitcnt vmcnt(4)
    s_barrier
    ds_read_b128 v[60:63], v17 offset:16384
    ds_read_b128 v[64:67], v17 offset:20480
    ds_read_b64_tr_b16 v[68:69], v21 offset:32768
    ds_read_b64_tr_b16 v[70:71], v21 offset:33792
    ds_read_b64_tr_b16 v[72:73], v21 offset:49152
    ds_read_b64_tr_b16 v[74:75], v21 offset:50176
    s_waitcnt lgkmcnt(6)
    v_mfma_f32_32x32x16_bf16 v[108:123], v[52:55], v[44:47], v[108:123]
    s_add_u32 m0, s46, 2048
    s_nop 0
    buffer_load_dwordx4 v12, s[12:15], s48 offen lds
    v_mfma_f32_32x32x16_bf16 v[124:139], v[52:55], v[48:51], v[124:139]
    s_add_u32 m0, s46, 3072
    s_nop 0
    buffer_load_dwordx4 v13, s[12:15], s48 offen lds
    s_add_u32 s47, s47, 128
    s_add_u32 s48, s48, s49
    s_add_u32 s69, s69, 1
    s_cmp_eq_u32 s69, 10
    s_cselect_b32 s47, 0, s47
    s_cselect_b32 s48, 0, s48
    s_cselect_b32 s69, 0, s69
    v_mfma_f32_32x32x16_bf16 v[140:155], v[56:59], v[44:47], v[140:155]
    v_mfma_f32_32x32x16_bf16 v[156:171], v[56:59], v[48:51], v[156:171]
    ds_read_b128 v[44:47], v14 offset:32768
    ds_read_b128 v[48:51], v14 offset:36864
    ds_read_b64_tr_b16 v[52:53], v22 offset:0
    ds_read_b64_tr_b16 v[54:55], v22 offset:1024
    ds_read_b64_tr_b16 v[56:57], v22 offset:16384
    ds_read_b64_tr_b16 v[58:59], v22 offset:17408
    s_waitcnt lgkmcnt(6)
    v_mfma_f32_32x32x16_bf16 v[108:123], v[68:71], v[60:63], v[108:123]
    v_mfma_f32_32x32x16_bf16 v[124:139], v[68:71], v[64:67], v[124:139]
    v_mfma_f32_32x32x16_bf16 v[140:155], v[72:75], v[60:63], v[140:155]
    v_mfma_f32_32x32x16_bf16 v[156:171], v[72:75], v[64:67], v[156:171]
    s_barrier
    ds_read_b128 v[60:63], v15 offset:32768
    ds_read_b128 v[64:67], v15 offset:36864
    ds_read_b64_tr_b16 v[68:69], v23 offset:0
    ds_read_b64_tr_b16 v[70:71], v23 offset:1024
    ds_read_b64_tr_b16 v[72:73], v23 offset:16384
    ds_read_b64_tr_b16 v[74:75], v23 offset:17408
    s_waitcnt lgkmcnt(6)
    v_mfma_f32_32x32x16_bf16 v[108:123], v[52:55], v[44:47], v[108:123]
    s_add_u32 m0, s45, 16384
    s_nop 0
    buffer_load_dwordx4 v8, s[84:87], s47 offen lds
    v_mfma_f32_32x32x16_bf16 v[124:139], v[52:55], v[48:51], v[124:139]
    v_mfma_f32_32x32x16_bf16 v[140:155], v[56:59], v[44:47], v[140:155]
    s_add_u32 m0, s45, 17408
    s_nop 0
    buffer_load_dwordx4 v9, s[84:87], s47 offen lds
    v_mfma_f32_32x32x16_bf16 v[156:171], v[56:59], v[48:51], v[156:171]
    ds_read_b128 v[44:47], v16 offset:32768
    ds_read_b128 v[48:51], v16 offset:36864
    ds_read_b64_tr_b16 v[52:53], v24 offset:0
    ds_read_b64_tr_b16 v[54:55], v24 offset:1024
    ds_read_b64_tr_b16 v[56:57], v24 offset:16384
    ds_read_b64_tr_b16 v[58:59], v24 offset:17408
    s_waitcnt lgkmcnt(6)
    v_mfma_f32_32x32x16_bf16 v[108:123], v[68:71], v[60:63], v[108:123]
    s_add_u32 m0, s46, 32768
    s_nop 0
    buffer_load_dwordx4 v10, s[12:15], s48 offen lds
    v_mfma_f32_32x32x16_bf16 v[124:139], v[68:71], v[64:67], v[124:139]
    v_mfma_f32_32x32x16_bf16 v[140:155], v[72:75], v[60:63], v[140:155]
    s_add_u32 m0, s46, 33792
    s_nop 0
    buffer_load_dwordx4 v11, s[12:15], s48 offen lds
    v_mfma_f32_32x32x16_bf16 v[156:171], v[72:75], v[64:67], v[156:171]
    s_waitcnt vmcnt(4)
    s_barrier
    ds_read_b128 v[60:63], v17 offset:32768
    ds_read_b128 v[64:67], v17 offset:36864
    ds_read_b64_tr_b16 v[68:69], v25 offset:0
    ds_read_b64_tr_b16 v[70:71], v25 offset:1024
    ds_read_b64_tr_b16 v[72:73], v25 offset:16384
    ds_read_b64_tr_b16 v[74:75], v25 offset:17408
    s_waitcnt lgkmcnt(6)
    v_mfma_f32_32x32x16_bf16 v[108:123], v[52:55], v[44:47], v[108:123]
    s_add_u32 m0, s46, 34816
    s_nop 0
    buffer_load_dwordx4 v12, s[12:15], s48 offen lds
    v_mfma_f32_32x32x16_bf16 v[124:139], v[52:55], v[48:51], v[124:139]
    s_add_u32 m0, s46, 35840
    s_nop 0
    buffer_load_dwordx4 v13, s[12:15], s48 offen lds
    s_add_u32 s47, s47, 128
    s_add_u32 s48, s48, s49
    s_add_u32 s69, s69, 1
    s_cmp_eq_u32 s69, 10
    s_cselect_b32 s47, 0, s47
    s_cselect_b32 s48, 0, s48
    s_cselect_b32 s69, 0, s69
    v_mfma_f32_32x32x16_bf16 v[140:155], v[56:59], v[44:47], v[140:155]
    v_mfma_f32_32x32x16_bf16 v[156:171], v[56:59], v[48:51], v[156:171]
    ds_read_b128 v[44:47], v14 offset:0
    ds_read_b128 v[48:51], v14 offset:4096
    ds_read_b64_tr_b16 v[52:53], v18 offset:0
    ds_read_b64_tr_b16 v[54:55], v18 offset:1024
    ds_read_b64_tr_b16 v[56:57], v18 offset:16384
    ds_read_b64_tr_b16 v[58:59], v18 offset:17408
    s_waitcnt lgkmcnt(6)
    v_mfma_f32_32x32x16_bf16 v[108:123], v[68:71], v[60:63], v[108:123]
    v_mfma_f32_32x32x16_bf16 v[124:139], v[68:71], v[64:67], v[124:139]
    v_mfma_f32_32x32x16_bf16 v[140:155], v[72:75], v[60:63], v[140:155]
    v_mfma_f32_32x32x16_bf16 v[156:171], v[72:75], v[64:67], v[156:171]
    s_barrier
    ds_read_b128 v[60:63], v15 offset:0
    ds_read_b128 v[64:67], v15 offset:4096
    ds_read_b64_tr_b16 v[68:69], v19 offset:0
    ds_read_b64_tr_b16 v[70:71], v19 offset:1024
    ds_read_b64_tr_b16 v[72:73], v19 offset:16384
    ds_read_b64_tr_b16 v[74:75], v19 offset:17408
    s_waitcnt lgkmcnt(6)
    v_mfma_f32_32x32x16_bf16 v[108:123], v[52:55], v[44:47], v[108:123]
    s_add_u32 m0, s45, 32768
    s_nop 0
    buffer_load_dwordx4 v8, s[84:87], s47 offen lds
    v_mfma_f32_32x32x16_bf16 v[124:139], v[52:55], v[48:51], v[124:139]
    v_mfma_f32_32x32x16_bf16 v[140:155], v[56:59], v[44:47], v[140:155]
    s_add_u32 m0, s45, 33792
    s_nop 0
    buffer_load_dwordx4 v9, s[84:87], s47 offen lds
    v_mfma_f32_32x32x16_bf16 v[156:171], v[56:59], v[48:51], v[156:171]
    ds_read_b128 v[44:47], v16 offset:0
    ds_read_b128 v[48:51], v16 offset:4096
    ds_read_b64_tr_b16 v[52:53], v20 offset:0
    ds_read_b64_tr_b16 v[54:55], v20 offset:1024
    ds_read_b64_tr_b16 v[56:57], v20 offset:16384
    ds_read_b64_tr_b16 v[58:59], v20 offset:17408
    s_waitcnt lgkmcnt(6)
    v_mfma_f32_32x32x16_bf16 v[108:123], v[68:71], v[60:63], v[108:123]
    s_add_u32 m0, s46, 65536
    s_nop 0
    buffer_load_dwordx4 v10, s[12:15], s48 offen lds
    v_mfma_f32_32x32x16_bf16 v[124:139], v[68:71], v[64:67], v[124:139]
    v_mfma_f32_32x32x16_bf16 v[140:155], v[72:75], v[60:63], v[140:155]
    s_add_u32 m0, s46, 66560
    s_nop 0
    buffer_load_dwordx4 v11, s[12:15], s48 offen lds
    v_mfma_f32_32x32x16_bf16 v[156:171], v[72:75], v[64:67], v[156:171]
    s_waitcnt vmcnt(4)
    s_barrier
    ds_read_b128 v[60:63], v17 offset:0
    ds_read_b128 v[64:67], v17 offset:4096
    ds_read_b64_tr_b16 v[68:69], v21 offset:0
    ds_read_b64_tr_b16 v[70:71], v21 offset:1024
    ds_read_b64_tr_b16 v[72:73], v21 offset:16384
    ds_read_b64_tr_b16 v[74:75], v21 offset:17408
    s_waitcnt lgkmcnt(6)
    v_mfma_f32_32x32x16_bf16 v[108:123], v[52:55], v[44:47], v[108:123]
    s_add_u32 m0, s46, 67584
    s_nop 0
    buffer_load_dwordx4 v12, s[12:15], s48 offen lds
    v_mfma_f32_32x32x16_bf16 v[124:139], v[52:55], v[48:51], v[124:139]
    s_add_u32 m0, s46, 68608
    s_nop 0
    buffer_load_dwordx4 v13, s[12:15], s48 offen lds
    s_add_u32 s47, s47, 128
    s_add_u32 s48, s48, s49
    s_add_u32 s69, s69, 1
    s_cmp_eq_u32 s69, 10
    s_cselect_b32 s47, 0, s47
    s_cselect_b32 s48, 0, s48
    s_cselect_b32 s69, 0, s69
    v_mfma_f32_32x32x16_bf16 v[140:155], v[56:59], v[44:47], v[140:155]
    v_mfma_f32_32x32x16_bf16 v[156:171], v[56:59], v[48:51], v[156:171]
    ds_read_b128 v[44:47], v14 offset:16384
    ds_read_b128 v[48:51], v14 offset:20480
    ds_read_b64_tr_b16 v[52:53], v18 offset:32768
    ds_read_b64_tr_b16 v[54:55], v18 offset:33792
    ds_read_b64_tr_b16 v[56:57], v18 offset:49152
    ds_read_b64_tr_b16 v[58:59], v18 offset:50176
    s_waitcnt lgkmcnt(6)
    v_mfma_f32_32x32x16_bf16 v[108:123], v[68:71], v[60:63], v[108:123]
    v_mfma_f32_32x32x16_bf16 v[124:139], v[68:71], v[64:67], v[124:139]
    v_mfma_f32_32x32x16_bf16 v[140:155], v[72:75], v[60:63], v[140:155]
    v_mfma_f32_32x32x16_bf16 v[156:171], v[72:75], v[64:67], v[156:171]
    s_barrier
    ds_read_b128 v[60:63], v15 offset:16384
    ds_read_b128 v[64:67], v15 offset:20480
    ds_read_b64_tr_b16 v[68:69], v19 offset:32768
    ds_read_b64_tr_b16 v[70:71], v19 offset:33792
    ds_read_b64_tr_b16 v[72:73], v19 offset:49152
    ds_read_b64_tr_b16 v[74:75], v19 offset:50176
    s_waitcnt lgkmcnt(6)
    v_mfma_f32_32x32x16_bf16 v[108:123], v[52:55], v[44:47], v[108:123]
    s_add_u32 m0, s45, 0
    s_nop 0
    buffer_load_dwordx4 v8, s[84:87], s47 offen lds
    v_mfma_f32_32x32x16_bf16 v[124:139], v[52:55], v[48:51], v[124:139]
    v_mfma_f32_32x32x16_bf16 v[140:155], v[56:59], v[44:47], v[140:155]
    s_add_u32 m0, s45, 1024
    s_nop 0
    buffer_load_dwordx4 v9, s[84:87], s47 offen lds
    v_mfma_f32_32x32x16_bf16 v[156:171], v[56:59], v[48:51], v[156:171]
    ds_read_b128 v[44:47], v16 offset:16384
    ds_read_b128 v[48:51], v16 offset:20480
    ds_read_b64_tr_b16 v[52:53], v20 offset:32768
    ds_read_b64_tr_b16 v[54:55], v20 offset:33792
    ds_read_b64_tr_b16 v[56:57], v20 offset:49152
    ds_read_b64_tr_b16 v[58:59], v20 offset:50176
    s_waitcnt lgkmcnt(6)
    v_mfma_f32_32x32x16_bf16 v[108:123], v[68:71], v[60:63], v[108:123]
    s_add_u32 m0, s46, 0
    s_nop 0
    buffer_load_dwordx4 v10, s[12:15], s48 offen lds
    v_mfma_f32_32x32x16_bf16 v[124:139], v[68:71], v[64:67], v[124:139]
    v_mfma_f32_32x32x16_bf16 v[140:155], v[72:75], v[60:63], v[140:155]
    s_add_u32 m0, s46, 1024
    s_nop 0
    buffer_load_dwordx4 v11, s[12:15], s48 offen lds
    v_mfma_f32_32x32x16_bf16 v[156:171], v[72:75], v[64:67], v[156:171]
    s_waitcnt vmcnt(4)
    s_barrier
    ds_read_b128 v[60:63], v17 offset:16384
    ds_read_b128 v[64:67], v17 offset:20480
    ds_read_b64_tr_b16 v[68:69], v21 offset:32768
    ds_read_b64_tr_b16 v[70:71], v21 offset:33792
    ds_read_b64_tr_b16 v[72:73], v21 offset:49152
    ds_read_b64_tr_b16 v[74:75], v21 offset:50176
    s_waitcnt lgkmcnt(6)
    v_mfma_f32_32x32x16_bf16 v[108:123], v[52:55], v[44:47], v[108:123]
    s_add_u32 m0, s46, 2048
    s_nop 0
    buffer_load_dwordx4 v12, s[12:15], s48 offen lds
    v_mfma_f32_32x32x16_bf16 v[124:139], v[52:55], v[48:51], v[124:139]
    s_add_u32 m0, s46, 3072
    s_nop 0
    buffer_load_dwordx4 v13, s[12:15], s48 offen lds
    s_add_u32 s47, s47, 128
    s_add_u32 s48, s48, s49
    s_add_u32 s69, s69, 1
    s_cmp_eq_u32 s69, 10
    s_cselect_b32 s47, 0, s47
    s_cselect_b32 s48, 0, s48
    s_cselect_b32 s69, 0, s69
    v_mfma_f32_32x32x16_bf16 v[140:155], v[56:59], v[44:47], v[140:155]
    v_mfma_f32_32x32x16_bf16 v[156:171], v[56:59], v[48:51], v[156:171]
    ds_read_b128 v[44:47], v14 offset:32768
    ds_read_b128 v[48:51], v14 offset:36864
    ds_read_b64_tr_b16 v[52:53], v22 offset:0
    ds_read_b64_tr_b16 v[54:55], v22 offset:1024
    ds_read_b64_tr_b16 v[56:57], v22 offset:16384
    ds_read_b64_tr_b16 v[58:59], v22 offset:17408
    s_waitcnt lgkmcnt(6)
    v_mfma_f32_32x32x16_bf16 v[108:123], v[68:71], v[60:63], v[108:123]
    buffer_load_dwordx3 v[76:78], v40, s[16:19], 0 offen offset:0 sc0 sc1
    buffer_load_dwordx3 v[80:82], v40, s[16:19], 0 offen offset:2048 sc0 sc1
    v_mfma_f32_32x32x16_bf16 v[124:139], v[68:71], v[64:67], v[124:139]
    buffer_load_dwordx3 v[84:86], v40, s[16:19], s89 offen offset:0 sc0 sc1
    buffer_load_dwordx3 v[88:90], v40, s[16:19], s89 offen offset:2048 sc0 sc1
    v_mfma_f32_32x32x16_bf16 v[140:155], v[72:75], v[60:63], v[140:155]
    buffer_load_dwordx3 v[92:94], v40, s[16:19], s90 offen offset:0 sc0 sc1
    buffer_load_dwordx3 v[96:98], v40, s[16:19], 0 offen offset:512 sc0 sc1
    v_mfma_f32_32x32x16_bf16 v[156:171], v[72:75], v[64:67], v[156:171]
    buffer_load_dwordx3 v[100:102], v40, s[16:19], 0 offen offset:2560 sc0 sc1
    buffer_load_dwordx3 v[104:106], v40, s[16:19], s89 offen offset:512 sc0 sc1
    ds_read_b128 v[60:63], v15 offset:32768
    ds_read_b128 v[64:67], v15 offset:36864
    ds_read_b64_tr_b16 v[68:69], v23 offset:0
    ds_read_b64_tr_b16 v[70:71], v23 offset:1024
    ds_read_b64_tr_b16 v[72:73], v23 offset:16384
    ds_read_b64_tr_b16 v[74:75], v23 offset:17408
    s_waitcnt lgkmcnt(6)
    v_mfma_f32_32x32x16_bf16 v[108:123], v[52:55], v[44:47], v[108:123]
    buffer_load_dwordx3 v[192:194], v40, s[16:19], s89 offen offset:2560 sc0 sc1
    buffer_load_dwordx3 v[196:198], v40, s[16:19], s90 offen offset:512 sc0 sc1
    v_mfma_f32_32x32x16_bf16 v[124:139], v[52:55], v[48:51], v[124:139]
    buffer_load_dwordx2 v[172:173], v41, s[16:19], 0 offen offset:0 sc0 sc1
    buffer_load_dwordx2 v[174:175], v41, s[16:19], 0 offen offset:2048 sc0 sc1
    v_mfma_f32_32x32x16_bf16 v[140:155], v[56:59], v[44:47], v[140:155]
    buffer_load_dwordx2 v[176:177], v41, s[16:19], s89 offen offset:0 sc0 sc1
    buffer_load_dwordx2 v[178:179], v41, s[16:19], s89 offen offset:2048 sc0 sc1
    v_mfma_f32_32x32x16_bf16 v[156:171], v[56:59], v[48:51], v[156:171]
    buffer_load_dwordx2 v[180:181], v41, s[16:19], s90 offen offset:0 sc0 sc1
    buffer_load_dwordx2 v[182:183], v41, s[16:19], 0 offen offset:1024 sc0 sc1
    ds_read_b128 v[44:47], v16 offset:32768
    ds_read_b128 v[48:51], v16 offset:36864
    ds_read_b64_tr_b16 v[52:53], v24 offset:0
    ds_read_b64_tr_b16 v[54:55], v24 offset:1024
    ds_read_b64_tr_b16 v[56:57], v24 offset:16384
    ds_read_b64_tr_b16 v[58:59], v24 offset:17408
    s_waitcnt lgkmcnt(6)
    v_mfma_f32_32x32x16_bf16 v[108:123], v[68:71], v[60:63], v[108:123]
    buffer_load_dwordx2 v[184:185], v41, s[16:19], 0 offen offset:3072 sc0 sc1
    buffer_load_dwordx2 v[186:187], v41, s[16:19], s89 offen offset:1024 sc0 sc1
    v_mfma_f32_32x32x16_bf16 v[124:139], v[68:71], v[64:67], v[124:139]
    buffer_load_dwordx2 v[188:189], v41, s[16:19], s89 offen offset:3072 sc0 sc1
    buffer_load_dwordx2 v[190:191], v41, s[16:19], s90 offen offset:1024 sc0 sc1
    v_mfma_f32_32x32x16_bf16 v[140:155], v[72:75], v[60:63], v[140:155]
    v_mfma_f32_32x32x16_bf16 v[156:171], v[72:75], v[64:67], v[156:171]
    s_waitcnt vmcnt(20)
    s_barrier
    ds_read_b128 v[60:63], v17 offset:32768
    ds_read_b128 v[64:67], v17 offset:36864
    ds_read_b64_tr_b16 v[68:69], v25 offset:0
    ds_read_b64_tr_b16 v[70:71], v25 offset:1024
    ds_read_b64_tr_b16 v[72:73], v25 offset:16384
    ds_read_b64_tr_b16 v[74:75], v25 offset:17408
    s_waitcnt lgkmcnt(6)
    v_mfma_f32_32x32x16_bf16 v[108:123], v[52:55], v[44:47], v[108:123]
    v_mfma_f32_32x32x16_bf16 v[124:139], v[52:55], v[48:51], v[124:139]
    v_mfma_f32_32x32x16_bf16 v[140:155], v[56:59], v[44:47], v[140:155]
    v_mfma_f32_32x32x16_bf16 v[156:171], v[56:59], v[48:51], v[156:171]
    ds_read_b128 v[44:47], v14 offset:0
    ds_read_b128 v[48:51], v14 offset:4096
    ds_read_b64_tr_b16 v[52:53], v18 offset:0
    ds_read_b64_tr_b16 v[54:55], v18 offset:1024
    ds_read_b64_tr_b16 v[56:57], v18 offset:16384
    ds_read_b64_tr_b16 v[58:59], v18 offset:17408
    s_waitcnt lgkmcnt(6)
    v_mfma_f32_32x32x16_bf16 v[108:123], v[68:71], v[60:63], v[108:123]
    v_mfma_f32_32x32x16_bf16 v[124:139], v[68:71], v[64:67], v[124:139]
    v_mfma_f32_32x32x16_bf16 v[140:155], v[72:75], v[60:63], v[140:155]
    v_mfma_f32_32x32x16_bf16 v[156:171], v[72:75], v[64:67], v[156:171]
    s_waitcnt vmcnt(0)
    ds_read_b128 v[60:63], v15 offset:0
    ds_read_b128 v[64:67], v15 offset:4096
    ds_read_b64_tr_b16 v[68:69], v19 offset:0
    ds_read_b64_tr_b16 v[70:71], v19 offset:1024
    ds_read_b64_tr_b16 v[72:73], v19 offset:16384
    ds_read_b64_tr_b16 v[74:75], v19 offset:17408
    s_waitcnt lgkmcnt(6)
    v_mfma_f32_32x32x16_bf16 v[108:123], v[52:55], v[44:47], v[108:123]
    v_subrev_u32 v78, s88, v78
    v_subrev_u32 v82, s88, v82
    v_subrev_u32 v86, s88, v86
    v_subrev_u32 v90, s88, v90
    v_subrev_u32 v94, s88, v94
    v_subrev_u32 v98, s88, v98
    v_subrev_u32 v102, s88, v102
    v_subrev_u32 v106, s88, v106
    v_subrev_u32 v194, s88, v194
    v_subrev_u32 v198, s88, v198
    v_subrev_u32 v173, s88, v173
    v_subrev_u32 v175, s88, v175
    v_mfma_f32_32x32x16_bf16 v[124:139], v[52:55], v[48:51], v[124:139]
    v_subrev_u32 v177, s88, v177
    v_subrev_u32 v179, s88, v179
    v_subrev_u32 v181, s88, v181
    v_subrev_u32 v183, s88, v183
    v_subrev_u32 v185, s88, v185
    v_subrev_u32 v187, s88, v187
    v_subrev_u32 v189, s88, v189
    v_subrev_u32 v191, s88, v191
    v_max3_u32 v206, v78, v82, v86
    v_max3_u32 v206, v206, v90, v94
    v_max3_u32 v206, v206, v98, v102
    v_max3_u32 v206, v206, v106, v194
    v_mfma_f32_32x32x16_bf16 v[140:155], v[56:59], v[44:47], v[140:155]
    v_max3_u32 v206, v206, v198, v173
    v_max3_u32 v206, v206, v175, v177
    v_max3_u32 v206, v206, v179, v181
    v_max3_u32 v206, v206, v183, v185
    v_max3_u32 v206, v206, v187, v189
    v_max_u32 v206, v206, v191
    v_cmp_gt_u32 vcc, 4700, v206
    s_cmp_eq_u64 vcc, -1
    s_cselect_b32 s92, 1, 0
    v_add_f32 v208, v76, v80
    v_add_f32 v209, v77, v81
    v_add_f32 v84, v84, v88
    v_mfma_f32_32x32x16_bf16 v[156:171], v[56:59], v[48:51], v[156:171]
    v_add_f32 v85, v85, v89
    v_add_f32 v208, v208, v92
    v_add_f32 v209, v209, v93
    v_add_f32 v208, v208, v84
    v_add_f32 v209, v209, v85
    v_add_f32 v224, v96, v100
    v_add_f32 v225, v97, v101
    v_add_f32 v104, v104, v192
    v_add_f32 v105, v105, v193
    v_add_f32 v224, v224, v196
    v_add_f32 v225, v225, v197
    v_add_f32 v224, v224, v104
    ds_read_b128 v[44:47], v16 offset:0
    ds_read_b128 v[48:51], v16 offset:4096
    ds_read_b64_tr_b16 v[52:53], v20 offset:0
    ds_read_b64_tr_b16 v[54:55], v20 offset:1024
    ds_read_b64_tr_b16 v[56:57], v20 offset:16384
    ds_read_b64_tr_b16 v[58:59], v20 offset:17408
    s_waitcnt lgkmcnt(6)
    v_mfma_f32_32x32x16_bf16 v[108:123], v[68:71], v[60:63], v[108:123]
    v_add_f32 v225, v225, v105
    v_add_f32 v240, v172, v174
    v_add_f32 v176, v176, v178
    v_add_f32 v240, v240, v180
    v_add_f32 v240, v240, v176
    v_add_f32 v241, v182, v184
    v_add_f32 v186, v186, v188
    v_add_f32 v241, v241, v190
    v_add_f32 v241, v241, v186
    s_nop 2
    v_mov_b32 v200, v208
    v_mov_b32 v201, v209
    v_mfma_f32_32x32x16_bf16 v[124:139], v[68:71], v[64:67], v[124:139]
    v_mov_b32 v202, v224
    v_mov_b32 v203, v225
    v_mov_b32 v204, v240
    v_mov_b32 v205, v241
    s_nop 1
    v_permlane32_swap_b32 v208, v200
    v_permlane32_swap_b32 v209, v201
    v_permlane32_swap_b32 v224, v202
    v_permlane32_swap_b32 v225, v203
    v_permlane32_swap_b32 v240, v204
    v_permlane32_swap_b32 v241, v205
    s_nop 1
    v_mfma_f32_32x32x16_bf16 v[140:155], v[72:75], v[60:63], v[140:155]
    v_add_f32 v208, v208, v200
    v_add_f32 v209, v209, v201
    v_add_f32 v224, v224, v202
    v_add_f32 v225, v225, v203
    v_add_f32 v240, v240, v204
    v_add_f32 v241, v241, v205
    v_mul_f32 v208, s64, v208
    v_mul_f32 v224, s64, v224
    v_mul_f32 v209, s64, v209
    v_mul_f32 v225, s64, v225
    v_fma_f32 v209, -v208, v208, v209
    v_fma_f32 v225, -v224, v224, v225
    v_mfma_f32_32x32x16_bf16 v[156:171], v[72:75], v[64:67], v[156:171]
    v_max_f32 v209, 0, v209
    v_max_f32 v225, 0, v225
    v_cvt_pk_bf16_f32 v210, v208, v208
    v_cvt_pk_bf16_f32 v226, v224, v224
    v_cvt_pk_bf16_f32 v211, v209, v209
    v_cvt_pk_bf16_f32 v227, v225, v225
    v_lshlrev_b32 v210, 16, v210
    v_lshlrev_b32 v226, 16, v226
    v_lshlrev_b32 v211, 16, v211
    v_lshlrev_b32 v227, 16, v227
    v_add_f32 v211, s65, v211
    v_add_f32 v227, s65, v227
    ds_read_b128 v[60:63], v17 offset:0
    ds_read_b128 v[64:67], v17 offset:4096
    ds_read_b64_tr_b16 v[68:69], v21 offset:0
    ds_read_b64_tr_b16 v[70:71], v21 offset:1024
    ds_read_b64_tr_b16 v[72:73], v21 offset:16384
    ds_read_b64_tr_b16 v[74:75], v21 offset:17408
    s_waitcnt lgkmcnt(6)
    v_mfma_f32_32x32x16_bf16 v[108:123], v[52:55], v[44:47], v[108:123]
    v_cvt_pk_bf16_f32 v211, v211, v211
    v_cvt_pk_bf16_f32 v227, v227, v227
    v_lshlrev_b32 v211, 16, v211
    v_lshlrev_b32 v227, 16, v227
    v_sqrt_f32 v211, v211
    v_sqrt_f32 v227, v227
    v_cvt_pk_bf16_f32 v211, v211, v211
    v_cvt_pk_bf16_f32 v227, v227, v227
    v_lshlrev_b32 v211, 16, v211
    v_lshlrev_b32 v227, 16, v227
    v_rcp_f32 v212, v211
    v_rcp_f32 v228, v227
    v_mfma_f32_32x32x16_bf16 v[124:139], v[52:55], v[48:51], v[124:139]
    v_sub_f32 v214, v208, v210
    v_sub_f32 v230, v224, v226
    v_fma_f32 v213, -v211, v212, 1.0
    v_fma_f32 v229, -v227, v228, 1.0
    v_fma_f32 v212, v212, v213, v212
    v_fma_f32 v228, v228, v229, v228
    v_mul_f32 v213, v210, v212
    v_mul_f32 v229, v226, v228
    v_mul_f32 v214, v214, v212
    v_mul_f32 v230, v230, v228
    v_mul_f32 v215, v209, v212
    v_mul_f32 v231, v225, v228
    v_mfma_f32_32x32x16_bf16 v[140:155], v[56:59], v[44:47], v[140:155]
    v_cvt_pk_bf16_f32 v214, v214, v214
    v_cvt_pk_bf16_f32 v230, v230, v230
    v_mul_f32 v215, v215, v212
    v_mul_f32 v231, v231, v228
    v_lshlrev_b32 v214, 16, v214
    v_lshlrev_b32 v230, 16, v230
    v_cvt_pk_bf16_f32 v215, v215, v215
    v_cvt_pk_bf16_f32 v231, v231, v231
    v_lshlrev_b32 v215, 16, v215
    v_lshlrev_b32 v231, 16, v231
    v_add_f32 v215, s65, v215
    v_add_f32 v231, s65, v231
    v_mfma_f32_32x32x16_bf16 v[156:171], v[56:59], v[48:51], v[156:171]
    v_cvt_pk_bf16_f32 v215, v215, v215
    v_cvt_pk_bf16_f32 v231, v231, v231
    v_lshlrev_b32 v215, 16, v215
    v_lshlrev_b32 v231, 16, v231
    v_sqrt_f32 v215, v215
    v_sqrt_f32 v231, v231
    v_cvt_pk_bf16_f32 v215, v215, v215
    v_cvt_pk_bf16_f32 v231, v231, v231
    v_lshlrev_b32 v215, 16, v215
    v_lshlrev_b32 v231, 16, v231
    v_rcp_f32 v216, v215
    v_rcp_f32 v232, v231
    s_waitcnt lgkmcnt(0)
    v_mfma_f32_32x32x16_bf16 v[108:123], v[68:71], v[60:63], v[108:123]
    v_mul_f32 v244, s66, v212
    v_mul_f32 v245, s66, v228
    v_fma_f32 v217, -v215, v216, 1.0
    v_fma_f32 v233, -v231, v232, 1.0
    v_fma_f32 v216, v216, v217, v216
    v_fma_f32 v232, v232, v233, v232
    v_mul_f32 v246, s66, v213
    v_mul_f32 v247, s66, v229
    v_sub_f32 v246, 0, v246
    v_sub_f32 v247, 0, v247
    v_mul_f32 v248, v212, v216
    v_mul_f32 v249, v228, v232
    v_mfma_f32_32x32x16_bf16 v[124:139], v[68:71], v[64:67], v[124:139]
    v_add_f32 v219, v213, v214
    v_add_f32 v235, v229, v230
    v_mul_f32 v219, v219, v216
    v_mul_f32 v235, v235, v232
    v_sub_f32 v250, 0, v219
    v_sub_f32 v251, 0, v235
    v_lshlrev_b32 v243, 16, v242
    ds_write_b32 v42, v240
    ds_write_b32 v42, v241 offset:128
    ds_write_b32 v42, v243 offset:256
    ds_write_b32 v42, v244 offset:384
    ds_write_b32 v42, v245 offset:512
    v_mfma_f32_32x32x16_bf16 v[140:155], v[72:75], v[60:63], v[140:155]
    ds_write_b32 v42, v246 offset:640
    ds_write_b32 v42, v247 offset:768
    v_mfma_f32_32x32x16_bf16 v[156:171], v[72:75], v[64:67], v[156:171]
    s_branch K1_EPI
K1_LOOPV:
    s_waitcnt vmcnt(7)
    s_barrier
    ds_read_b128 v[44:47], v14 offset:0
    ds_read_b128 v[48:51], v14 offset:4096
    ds_read_b64_tr_b16 v[52:53], v18 offset:0
    ds_read_b64_tr_b16 v[54:55], v18 offset:1024
    ds_read_b64_tr_b16 v[56:57], v18 offset:16384
    ds_read_b64_tr_b16 v[58:59], v18 offset:17408
    ds_read_b128 v[60:63], v15 offset:0
    ds_read_b128 v[64:67], v15 offset:4096
    ds_read_b64_tr_b16 v[68:69], v19 offset:0
    ds_read_b64_tr_b16 v[70:71], v19 offset:1024
    ds_read_b64_tr_b16 v[72:73], v19 offset:16384
    ds_read_b64_tr_b16 v[74:75], v19 offset:17408
    s_waitcnt lgkmcnt(6)
    v_mfma_f32_32x32x16_bf16 v[108:123], v[44:47], v[52:55], 0
    v_lshlrev_b32 v200, 16, v44
    v_and_b32 v201, 0xffff0000, v44
    v_add_f32 v172, v172, v200
    v_add_f32 v173, v173, v201
    v_fmac_f32 v176, v200, v200
    v_fmac_f32 v177, v201, v201
    v_lshlrev_b32 v202, 16, v45
    v_and_b32 v203, 0xffff0000, v45
    v_add_f32 v172, v172, v202
    v_add_f32 v173, v173, v203
    v_fmac_f32 v176, v202, v202
    v_fmac_f32 v177, v203, v203
    v_lshlrev_b32 v204, 16, v46
    v_and_b32 v205, 0xffff0000, v46
    v_add_f32 v172, v172, v204
    v_add_f32 v173, v173, v205
    v_fmac_f32 v176, v204, v204
    v_fmac_f32 v177, v205, v205
    v_lshlrev_b32 v206, 16, v47
    v_and_b32 v207, 0xffff0000, v47
    s_add_u32 m0, s45, 32768
    s_nop 0
    buffer_load_dwordx4 v8, s[84:87], s47 offen lds
    v_mfma_f32_32x32x16_bf16 v[124:139], v[48:51], v[52:55], 0
    v_add_f32 v172, v172, v206
    v_add_f32 v173, v173, v207
    v_fmac_f32 v176, v206, v206
    v_fmac_f32 v177, v207, v207
    v_lshlrev_b32 v200, 16, v48
    v_and_b32 v201, 0xffff0000, v48
    v_add_f32 v174, v174, v200
    v_add_f32 v175, v175, v201
    v_fmac_f32 v178, v200, v200
    v_fmac_f32 v179, v201, v201
    v_lshlrev_b32 v202, 16, v49
    v_and_b32 v203, 0xffff0000, v49
    v_add_f32 v174, v174, v202
    v_add_f32 v175, v175, v203
    v_fmac_f32 v178, v202, v202
    v_fmac_f32 v179, v203, v203
    v_lshlrev_b32 v204, 16, v50
    v_and_b32 v205, 0xffff0000, v50
    v_add_f32 v174, v174, v204
    v_add_f32 v175, v175, v205
    v_mfma_f32_32x32x16_bf16 v[140:155], v[56:59], v[44:47], 0
    v_fmac_f32 v178, v204, v204
    v_fmac_f32 v179, v205, v205
    v_lshlrev_b32 v206, 16, v51
    v_and_b32 v207, 0xffff0000, v51
    v_add_f32 v174, v174, v206
    v_add_f32 v175, v175, v207
    v_fmac_f32 v178, v206, v206
    v_fmac_f32 v179, v207, v207
    v_lshlrev_b32 v200, 16, v52
    v_and_b32 v201, 0xffff0000, v52
    v_add_f32 v180, v180, v200
    v_add_f32 v181, v181, v201
    v_lshlrev_b32 v202, 16, v53
    v_and_b32 v203, 0xffff0000, v53
    v_add_f32 v180, v180, v202
    v_add_f32 v181, v181, v203
    v_lshlrev_b32 v204, 16, v54
    v_and_b32 v205, 0xffff0000, v54
    v_add_f32 v180, v180, v204
    v_add_f32 v181, v181, v205
    s_add_u32 m0, s45, 33792
    s_nop 0
    buffer_load_dwordx4 v9, s[84:87], s47 offen lds
    v_mfma_f32_32x32x16_bf16 v[156:171], v[56:59], v[48:51], 0
    v_lshlrev_b32 v206, 16, v55
    v_and_b32 v207, 0xffff0000, v55
    v_add_f32 v180, v180, v206
    v_add_f32 v181, v181, v207
    v_lshlrev_b32 v200, 16, v56
    v_and_b32 v201, 0xffff0000, v56
    v_add_f32 v182, v182, v200
    v_add_f32 v183, v183, v201
    v_lshlrev_b32 v202, 16, v57
    v_and_b32 v203, 0xffff0000, v57
    v_add_f32 v182, v182, v202
    v_add_f32 v183, v183, v203
    v_lshlrev_b32 v204, 16, v58
    v_and_b32 v205, 0xffff0000, v58
    v_add_f32 v182, v182, v204
    v_add_f32 v183, v183, v205
    v_lshlrev_b32 v206, 16, v59
    v_and_b32 v207, 0xffff0000, v59
    v_add_f32 v182, v182, v206
    v_add_f32 v183, v183, v207
    ds_read_b128 v[44:47], v16 offset:0
    ds_read_b128 v[48:51], v16 offset:4096
    ds_read_b64_tr_b16 v[52:53], v20 offset:0
    ds_read_b64_tr_b16 v[54:55], v20 offset:1024
    ds_read_b64_tr_b16 v[56:57], v20 offset:16384
    ds_read_b64_tr_b16 v[58:59], v20 offset:17408
    s_waitcnt lgkmcnt(6)
    v_mfma_f32_32x32x16_bf16 v[108:123], v[60:63], v[68:71], v[108:123]
    v_lshlrev_b32 v200, 16, v68
    v_and_b32 v201, 0xffff0000, v68
    v_add_f32 v180, v180, v200
    v_add_f32 v181, v181, v201
    v_lshlrev_b32 v202, 16, v69
    v_and_b32 v203, 0xffff0000, v69
    v_add_f32 v180, v180, v202
    v_add_f32 v181, v181, v203
    s_add_u32 m0, s46, 65536
    s_nop 0
    buffer_load_dwordx4 v10, s[12:15], s48 offen lds
    v_mfma_f32_32x32x16_bf16 v[124:139], v[64:67], v[68:71], v[124:139]
    v_lshlrev_b32 v204, 16, v70
    v_and_b32 v205, 0xffff0000, v70
    v_add_f32 v180, v180, v204
    v_add_f32 v181, v181, v205
    v_lshlrev_b32 v206, 16, v71
    v_and_b32 v207, 0xffff0000, v71
    v_add_f32 v180, v180, v206
    v_add_f32 v181, v181, v207
    v_mfma_f32_32x32x16_bf16 v[140:155], v[72:75], v[60:63], v[140:155]
    v_lshlrev_b32 v200, 16, v72
    v_and_b32 v201, 0xffff0000, v72
    v_add_f32 v182, v182, v200
    v_add_f32 v183, v183, v201
    v_lshlrev_b32 v202, 16, v73
    v_and_b32 v203, 0xffff0000, v73
    v_add_f32 v182, v182, v202
    v_add_f32 v183, v183, v203
    s_add_u32 m0, s46, 66560
    s_nop 0
    buffer_load_dwordx4 v11, s[12:15], s48 offen lds
    v_mfma_f32_32x32x16_bf16 v[156:171], v[72:75], v[64:67], v[156:171]
    v_lshlrev_b32 v204, 16, v74
    v_and_b32 v205, 0xffff0000, v74
    v_add_f32 v182, v182, v204
    v_add_f32 v183, v183, v205
    v_lshlrev_b32 v206, 16, v75
    v_and_b32 v207, 0xffff0000, v75
    v_add_f32 v182, v182, v206
    v_add_f32 v183, v183, v207
    s_waitcnt vmcnt(5)
    s_barrier
    ds_read_b128 v[60:63], v17 offset:0
    ds_read_b128 v[64:67], v17 offset:4096
    ds_read_b64_tr_b16 v[68:69], v21 offset:0
    ds_read_b64_tr_b16 v[70:71], v21 offset:1024
    ds_read_b64_tr_b16 v[72:73], v21 offset:16384
    ds_read_b64_tr_b16 v[74:75], v21 offset:17408
    s_waitcnt lgkmcnt(6)
    v_mfma_f32_32x32x16_bf16 v[108:123], v[44:47], v[52:55], v[108:123]
    v_add_f32 v200, v172, v173
    v_add_f32 v201, v176, v177
    v_add_f32 v202, v174, v175
    s_add_u32 m0, s46, 67584
    s_nop 0
    buffer_load_dwordx4 v12, s[12:15], s48 offen lds
    v_mfma_f32_32x32x16_bf16 v[124:139], v[48:51], v[52:55], v[124:139]
    v_add_f32 v203, v178, v179
    v_add_f32 v204, v180, v181
    v_add_f32 v205, v182, v183
    s_add_u32 m0, s46, 68608
    s_nop 0
    buffer_load_dwordx4 v13, s[12:15], s48 offen lds
    s_add_u32 s47, s47, 128
    s_add_u32 s48, s48, s49
    s_add_u32 s69, s69, 1
    s_cmp_eq_u32 s69, 10
    s_cselect_b32 s47, 0, s47
    s_cselect_b32 s48, 0, s48
    s_cselect_b32 s69, 0, s69
    v_mfma_f32_32x32x16_bf16 v[140:155], v[56:59], v[44:47], v[140:155]
    ds_write_b64 v34, v[200:201]
    ds_write_b64 v34, v[202:203] offset:2048
    ds_write_b32 v35, v204
    v_mfma_f32_32x32x16_bf16 v[156:171], v[56:59], v[48:51], v[156:171]
    ds_write_b32 v35, v205 offset:2048
    ds_read_b128 v[44:47], v14 offset:16384
    ds_read_b128 v[48:51], v14 offset:20480
    ds_read_b64_tr_b16 v[52:53], v18 offset:32768
    ds_read_b64_tr_b16 v[54:55], v18 offset:33792
    ds_read_b64_tr_b16 v[56:57], v18 offset:49152
    ds_read_b64_tr_b16 v[58:59], v18 offset:50176
    s_waitcnt lgkmcnt(6)
    v_mfma_f32_32x32x16_bf16 v[108:123], v[60:63], v[68:71], v[108:123]
    v_mfma_f32_32x32x16_bf16 v[124:139], v[64:67], v[68:71], v[124:139]
    v_mfma_f32_32x32x16_bf16 v[140:155], v[72:75], v[60:63], v[140:155]
    v_mfma_f32_32x32x16_bf16 v[156:171], v[72:75], v[64:67], v[156:171]
    s_barrier
    ds_read_b64 v[208:209], v36 offset:0
    ds_read_b64 v[210:211], v36 offset:256
    ds_read_b64 v[212:213], v36 offset:512
    ds_read_b64 v[214:215], v36 offset:768
    ds_read_b64 v[216:217], v36 offset:1024
    ds_read_b64 v[218:219], v36 offset:1280
    ds_read_b64 v[220:221], v36 offset:1536
    ds_read_b64 v[222:223], v36 offset:1792
    ds_read_b32 v224, v37 offset:0
    ds_read_b32 v225, v37 offset:128
    ds_read_b32 v226, v37 offset:256
    ds_read_b32 v227, v37 offset:384
    ds_read_b128 v[60:63], v15 offset:16384
    ds_read_b128 v[64:67], v15 offset:20480
    ds_read_b64_tr_b16 v[68:69], v19 offset:32768
    ds_read_b64_tr_b16 v[70:71], v19 offset:33792
    ds_read_b64_tr_b16 v[72:73], v19 offset:49152
    ds_read_b64_tr_b16 v[74:75], v19 offset:50176
    s_waitcnt lgkmcnt(6)
    v_mfma_f32_32x32x16_bf16 v[108:123], v[44:47], v[52:55], v[108:123]
    s_add_u32 m0, s45, 0
    s_nop 0
    buffer_load_dwordx4 v8, s[84:87], s47 offen lds
    v_mfma_f32_32x32x16_bf16 v[124:139], v[48:51], v[52:55], v[124:139]
    v_mfma_f32_32x32x16_bf16 v[140:155], v[56:59], v[44:47], v[140:155]
    s_add_u32 m0, s45, 1024
    s_nop 0
    buffer_load_dwordx4 v9, s[84:87], s47 offen lds
    v_mfma_f32_32x32x16_bf16 v[156:171], v[56:59], v[48:51], v[156:171]
    ds_read_b128 v[44:47], v16 offset:16384
    ds_read_b128 v[48:51], v16 offset:20480
    ds_read_b64_tr_b16 v[52:53], v20 offset:32768
    ds_read_b64_tr_b16 v[54:55], v20 offset:33792
    ds_read_b64_tr_b16 v[56:57], v20 offset:49152
    ds_read_b64_tr_b16 v[58:59], v20 offset:50176
    s_waitcnt lgkmcnt(6)
    v_mfma_f32_32x32x16_bf16 v[108:123], v[60:63], v[68:71], v[108:123]
    v_add_f32 v208, v208, v210
    v_add_f32 v209, v209, v211
    v_add_f32 v208, v208, v212
    v_add_f32 v209, v209, v213
    v_add_f32 v208, v208, v214
    s_add_u32 m0, s46, 0
    s_nop 0
    buffer_load_dwordx4 v10, s[12:15], s48 offen lds
    v_mfma_f32_32x32x16_bf16 v[124:139], v[64:67], v[68:71], v[124:139]
    v_add_f32 v209, v209, v215
    v_add_f32 v208, v208, v216
    v_add_f32 v209, v209, v217
    v_add_f32 v208, v208, v218
    v_add_f32 v209, v209, v219
    v_mfma_f32_32x32x16_bf16 v[140:155], v[72:75], v[60:63], v[140:155]
    v_add_f32 v208, v208, v220
    v_add_f32 v209, v209, v221
    v_add_f32 v208, v208, v222
    v_add_f32 v209, v209, v223
    v_add_f32 v224, v224, v225
    s_add_u32 m0, s46, 1024
    s_nop 0
    buffer_load_dwordx4 v11, s[12:15], s48 offen lds
    v_mfma_f32_32x32x16_bf16 v[156:171], v[72:75], v[64:67], v[156:171]
    v_add_f32 v226, v226, v227
    v_add_f32 v224, v224, v226
    s_waitcnt vmcnt(4)
    s_barrier
    ds_read_b128 v[60:63], v17 offset:16384
    ds_read_b128 v[64:67], v17 offset:20480
    ds_read_b64_tr_b16 v[68:69], v21 offset:32768
    ds_read_b64_tr_b16 v[70:71], v21 offset:33792
    ds_read_b64_tr_b16 v[72:73], v21 offset:49152
    ds_read_b64_tr_b16 v[74:75], v21 offset:50176
    s_waitcnt lgkmcnt(6)
    v_mfma_f32_32x32x16_bf16 v[108:123], v[44:47], v[52:55], v[108:123]
    s_add_u32 m0, s46, 2048
    s_nop 0
    buffer_load_dwordx4 v12, s[12:15], s48 offen lds
    v_mfma_f32_32x32x16_bf16 v[124:139], v[48:51], v[52:55], v[124:139]
    s_add_u32 m0, s46, 3072
    s_nop 0
    buffer_load_dwordx4 v13, s[12:15], s48 offen lds
    s_add_u32 s47, s47, 128
    s_add_u32 s48, s48, s49
    s_add_u32 s69, s69, 1
    s_cmp_eq_u32 s69, 10
    s_cselect_b32 s47, 0, s47
    s_cselect_b32 s48, 0, s48
    s_cselect_b32 s69, 0, s69
    v_mfma_f32_32x32x16_bf16 v[140:155], v[56:59], v[44:47], v[140:155]
    v_mfma_f32_32x32x16_bf16 v[156:171], v[56:59], v[48:51], v[156:171]
    ds_read_b128 v[44:47], v14 offset:32768
    ds_read_b128 v[48:51], v14 offset:36864
    ds_read_b64_tr_b16 v[52:53], v22 offset:0
    ds_read_b64_tr_b16 v[54:55], v22 offset:1024
    ds_read_b64_tr_b16 v[56:57], v22 offset:16384
    ds_read_b64_tr_b16 v[58:59], v22 offset:17408
    s_waitcnt lgkmcnt(6)
    v_mfma_f32_32x32x16_bf16 v[108:123], v[60:63], v[68:71], v[108:123]
    v_mfma_f32_32x32x16_bf16 v[124:139], v[64:67], v[68:71], v[124:139]
    v_mfma_f32_32x32x16_bf16 v[140:155], v[72:75], v[60:63], v[140:155]
    v_mfma_f32_32x32x16_bf16 v[156:171], v[72:75], v[64:67], v[156:171]
    v_mov_b32 v210, s6
    v_mov_b32 v211, 0
    v_mov_b32 v225, s6
    buffer_store_dwordx4 v[208:211], v38, s[16:19], 0 offen sc0 sc1
    buffer_store_dwordx2 v[224:225], v39, s[16:19], 0 offen sc0 sc1
    s_barrier
    ds_read_b128 v[60:63], v15 offset:32768
    ds_read_b128 v[64:67], v15 offset:36864
    ds_read_b64_tr_b16 v[68:69], v23 offset:0
    ds_read_b64_tr_b16 v[70:71], v23 offset:1024
    ds_read_b64_tr_b16 v[72:73], v23 offset:16384
    ds_read_b64_tr_b16 v[74:75], v23 offset:17408
    s_waitcnt lgkmcnt(6)
    v_mfma_f32_32x32x16_bf16 v[108:123], v[44:47], v[52:55], v[108:123]
    s_add_u32 m0, s45, 16384
    s_nop 0
    buffer_load_dwordx4 v8, s[84:87], s47 offen lds
    v_mfma_f32_32x32x16_bf16 v[124:139], v[48:51], v[52:55], v[124:139]
    v_mfma_f32_32x32x16_bf16 v[140:155], v[56:59], v[44:47], v[140:155]
    s_add_u32 m0, s45, 17408
    s_nop 0
    buffer_load_dwordx4 v9, s[84:87], s47 offen lds
    v_mfma_f32_32x32x16_bf16 v[156:171], v[56:59], v[48:51], v[156:171]
    ds_read_b128 v[44:47], v16 offset:32768
    ds_read_b128 v[48:51], v16 offset:36864
    ds_read_b64_tr_b16 v[52:53], v24 offset:0
    ds_read_b64_tr_b16 v[54:55], v24 offset:1024
    ds_read_b64_tr_b16 v[56:57], v24 offset:16384
    ds_read_b64_tr_b16 v[58:59], v24 offset:17408
    s_waitcnt lgkmcnt(6)
    v_mfma_f32_32x32x16_bf16 v[108:123], v[60:63], v[68:71], v[108:123]
    s_add_u32 m0, s46, 32768
    s_nop 0
    buffer_load_dwordx4 v10, s[12:15], s48 offen lds
    v_mfma_f32_32x32x16_bf16 v[124:139], v[64:67], v[68:71], v[124:139]
    v_mfma_f32_32x32x16_bf16 v[140:155], v[72:75], v[60:63], v[140:155]
    s_add_u32 m0, s46, 33792
    s_nop 0
    buffer_load_dwordx4 v11, s[12:15], s48 offen lds
    v_mfma_f32_32x32x16_bf16 v[156:171], v[72:75], v[64:67], v[156:171]
    s_waitcnt vmcnt(6)
    s_barrier
    ds_read_b128 v[60:63], v17 offset:32768
    ds_read_b128 v[64:67], v17 offset:36864
    ds_read_b64_tr_b16 v[68:69], v25 offset:0
    ds_read_b64_tr_b16 v[70:71], v25 offset:1024
    ds_read_b64_tr_b16 v[72:73], v25 offset:16384
    ds_read_b64_tr_b16 v[74:75], v25 offset:17408
    s_waitcnt lgkmcnt(6)
    v_mfma_f32_32x32x16_bf16 v[108:123], v[44:47], v[52:55], v[108:123]
    s_add_u32 m0, s46, 34816
    s_nop 0
    buffer_load_dwordx4 v12, s[12:15], s48 offen lds
    v_mfma_f32_32x32x16_bf16 v[124:139], v[48:51], v[52:55], v[124:139]
    s_add_u32 m0, s46, 35840
    s_nop 0
    buffer_load_dwordx4 v13, s[12:15], s48 offen lds
    s_add_u32 s47, s47, 128
    s_add_u32 s48, s48, s49
    s_add_u32 s69, s69, 1
    s_cmp_eq_u32 s69, 10
    s_cselect_b32 s47, 0, s47
    s_cselect_b32 s48, 0, s48
    s_cselect_b32 s69, 0, s69
    v_mfma_f32_32x32x16_bf16 v[140:155], v[56:59], v[44:47], v[140:155]
    v_mfma_f32_32x32x16_bf16 v[156:171], v[56:59], v[48:51], v[156:171]
    ds_read_b128 v[44:47], v14 offset:0
    ds_read_b128 v[48:51], v14 offset:4096
    ds_read_b64_tr_b16 v[52:53], v18 offset:0
    ds_read_b64_tr_b16 v[54:55], v18 offset:1024
    ds_read_b64_tr_b16 v[56:57], v18 offset:16384
    ds_read_b64_tr_b16 v[58:59], v18 offset:17408
    s_waitcnt lgkmcnt(6)
    v_mfma_f32_32x32x16_bf16 v[108:123], v[60:63], v[68:71], v[108:123]
    v_mfma_f32_32x32x16_bf16 v[124:139], v[64:67], v[68:71], v[124:139]
    v_mfma_f32_32x32x16_bf16 v[140:155], v[72:75], v[60:63], v[140:155]
    v_mfma_f32_32x32x16_bf16 v[156:171], v[72:75], v[64:67], v[156:171]
    s_barrier
    ds_read_b128 v[60:63], v15 offset:0
    ds_read_b128 v[64:67], v15 offset:4096
    ds_read_b64_tr_b16 v[68:69], v19 offset:0
    ds_read_b64_tr_b16 v[70:71], v19 offset:1024
    ds_read_b64_tr_b16 v[72:73], v19 offset:16384
    ds_read_b64_tr_b16 v[74:75], v19 offset:17408
    s_waitcnt lgkmcnt(6)
    v_mfma_f32_32x32x16_bf16 v[108:123], v[44:47], v[52:55], v[108:123]
    s_add_u32 m0, s45, 32768
    s_nop 0
    buffer_load_dwordx4 v8, s[84:87], s47 offen lds
    v_mfma_f32_32x32x16_bf16 v[124:139], v[48:51], v[52:55], v[124:139]
    v_mfma_f32_32x32x16_bf16 v[140:155], v[56:59], v[44:47], v[140:155]
    s_add_u32 m0, s45, 33792
    s_nop 0
    buffer_load_dwordx4 v9, s[84:87], s47 offen lds
    v_mfma_f32_32x32x16_bf16 v[156:171], v[56:59], v[48:51], v[156:171]
    ds_read_b128 v[44:47], v16 offset:0
    ds_read_b128 v[48:51], v16 offset:4096
    ds_read_b64_tr_b16 v[52:53], v20 offset:0
    ds_read_b64_tr_b16 v[54:55], v20 offset:1024
    ds_read_b64_tr_b16 v[56:57], v20 offset:16384
    ds_read_b64_tr_b16 v[58:59], v20 offset:17408
    s_waitcnt lgkmcnt(6)
    v_mfma_f32_32x32x16_bf16 v[108:123], v[60:63], v[68:71], v[108:123]
    s_add_u32 m0, s46, 65536
    s_nop 0
    buffer_load_dwordx4 v10, s[12:15], s48 offen lds
    v_mfma_f32_32x32x16_bf16 v[124:139], v[64:67], v[68:71], v[124:139]
    v_mfma_f32_32x32x16_bf16 v[140:155], v[72:75], v[60:63], v[140:155]
    s_add_u32 m0, s46, 66560
    s_nop 0
    buffer_load_dwordx4 v11, s[12:15], s48 offen lds
    v_mfma_f32_32x32x16_bf16 v[156:171], v[72:75], v[64:67], v[156:171]
    s_waitcnt vmcnt(4)
    s_barrier
    ds_read_b128 v[60:63], v17 offset:0
    ds_read_b128 v[64:67], v17 offset:4096
    ds_read_b64_tr_b16 v[68:69], v21 offset:0
    ds_read_b64_tr_b16 v[70:71], v21 offset:1024
    ds_read_b64_tr_b16 v[72:73], v21 offset:16384
    ds_read_b64_tr_b16 v[74:75], v21 offset:17408
    s_waitcnt lgkmcnt(6)
    v_mfma_f32_32x32x16_bf16 v[108:123], v[44:47], v[52:55], v[108:123]
    s_add_u32 m0, s46, 67584
    s_nop 0
    buffer_load_dwordx4 v12, s[12:15], s48 offen lds
    v_mfma_f32_32x32x16_bf16 v[124:139], v[48:51], v[52:55], v[124:139]
    s_add_u32 m0, s46, 68608
    s_nop 0
    buffer_load_dwordx4 v13, s[12:15], s48 offen lds
    s_add_u32 s47, s47, 128
    s_add_u32 s48, s48, s49
    s_add_u32 s69, s69, 1
    s_cmp_eq_u32 s69, 10
    s_cselect_b32 s47, 0, s47
    s_cselect_b32 s48, 0, s48
    s_cselect_b32 s69, 0, s69
    v_mfma_f32_32x32x16_bf16 v[140:155], v[56:59], v[44:47], v[140:155]
    v_mfma_f32_32x32x16_bf16 v[156:171], v[56:59], v[48:51], v[156:171]
    ds_read_b128 v[44:47], v14 offset:16384
    ds_read_b128 v[48:51], v14 offset:20480
    ds_read_b64_tr_b16 v[52:53], v18 offset:32768
    ds_read_b64_tr_b16 v[54:55], v18 offset:33792
    ds_read_b64_tr_b16 v[56:57], v18 offset:49152
    ds_read_b64_tr_b16 v[58:59], v18 offset:50176
    s_waitcnt lgkmcnt(6)
    v_mfma_f32_32x32x16_bf16 v[108:123], v[60:63], v[68:71], v[108:123]
    v_mfma_f32_32x32x16_bf16 v[124:139], v[64:67], v[68:71], v[124:139]
    v_mfma_f32_32x32x16_bf16 v[140:155], v[72:75], v[60:63], v[140:155]
    v_mfma_f32_32x32x16_bf16 v[156:171], v[72:75], v[64:67], v[156:171]
    s_barrier
    ds_read_b128 v[60:63], v15 offset:16384
    ds_read_b128 v[64:67], v15 offset:20480
    ds_read_b64_tr_b16 v[68:69], v19 offset:32768
    ds_read_b64_tr_b16 v[70:71], v19 offset:33792
    ds_read_b64_tr_b16 v[72:73], v19 offset:49152
    ds_read_b64_tr_b16 v[74:75], v19 offset:50176
    s_waitcnt lgkmcnt(6)
    v_mfma_f32_32x32x16_bf16 v[108:123], v[44:47], v[52:55], v[108:123]
    s_add_u32 m0, s45, 0
    s_nop 0
    buffer_load_dwordx4 v8, s[84:87], s47 offen lds
    v_mfma_f32_32x32x16_bf16 v[124:139], v[48:51], v[52:55], v[124:139]
    v_mfma_f32_32x32x16_bf16 v[140:155], v[56:59], v[44:47], v[140:155]
    s_add_u32 m0, s45, 1024
    s_nop 0
    buffer_load_dwordx4 v9, s[84:87], s47 offen lds
    v_mfma_f32_32x32x16_bf16 v[156:171], v[56:59], v[48:51], v[156:171]
    ds_read_b128 v[44:47], v16 offset:16384
    ds_read_b128 v[48:51], v16 offset:20480
    ds_read_b64_tr_b16 v[52:53], v20 offset:32768
    ds_read_b64_tr_b16 v[54:55], v20 offset:33792
    ds_read_b64_tr_b16 v[56:57], v20 offset:49152
    ds_read_b64_tr_b16 v[58:59], v20 offset:50176
    s_waitcnt lgkmcnt(6)
    v_mfma_f32_32x32x16_bf16 v[108:123], v[60:63], v[68:71], v[108:123]
    s_add_u32 m0, s46, 0
    s_nop 0
    buffer_load_dwordx4 v10, s[12:15], s48 offen lds
    v_mfma_f32_32x32x16_bf16 v[124:139], v[64:67], v[68:71], v[124:139]
    v_mfma_f32_32x32x16_bf16 v[140:155], v[72:75], v[60:63], v[140:155]
    s_add_u32 m0, s46, 1024
    s_nop 0
    buffer_load_dwordx4 v11, s[12:15], s48 offen lds
    v_mfma_f32_32x32x16_bf16 v[156:171], v[72:75], v[64:67], v[156:171]
    s_waitcnt vmcnt(4)
    s_barrier
    ds_read_b128 v[60:63], v17 offset:16384
    ds_read_b128 v[64:67], v17 offset:20480
    ds_read_b64_tr_b16 v[68:69], v21 offset:32768
    ds_read_b64_tr_b16 v[70:71], v21 offset:33792
    ds_read_b64_tr_b16 v[72:73], v21 offset:49152
    ds_read_b64_tr_b16 v[74:75], v21 offset:50176
    s_waitcnt lgkmcnt(6)
    v_mfma_f32_32x32x16_bf16 v[108:123], v[44:47], v[52:55], v[108:123]
    s_add_u32 m0, s46, 2048
    s_nop 0
    buffer_load_dwordx4 v12, s[12:15], s48 offen lds
    v_mfma_f32_32x32x16_bf16 v[124:139], v[48:51], v[52:55], v[124:139]
    s_add_u32 m0, s46, 3072
    s_nop 0
    buffer_load_dwordx4 v13, s[12:15], s48 offen lds
    s_add_u32 s47, s47, 128
    s_add_u32 s48, s48, s49
    s_add_u32 s69, s69, 1
    s_cmp_eq_u32 s69, 10
    s_cselect_b32 s47, 0, s47
    s_cselect_b32 s48, 0, s48
    s_cselect_b32 s69, 0, s69
    v_mfma_f32_32x32x16_bf16 v[140:155], v[56:59], v[44:47], v[140:155]
    v_mfma_f32_32x32x16_bf16 v[156:171], v[56:59], v[48:51], v[156:171]
    ds_read_b128 v[44:47], v14 offset:32768
    ds_read_b128 v[48:51], v14 offset:36864
    ds_read_b64_tr_b16 v[52:53], v22 offset:0
    ds_read_b64_tr_b16 v[54:55], v22 offset:1024
    ds_read_b64_tr_b16 v[56:57], v22 offset:16384
    ds_read_b64_tr_b16 v[58:59], v22 offset:17408
    s_waitcnt lgkmcnt(6)
    v_mfma_f32_32x32x16_bf16 v[108:123], v[60:63], v[68:71], v[108:123]
    v_mfma_f32_32x32x16_bf16 v[124:139], v[64:67], v[68:71], v[124:139]
    v_mfma_f32_32x32x16_bf16 v[140:155], v[72:75], v[60:63], v[140:155]
    v_mfma_f32_32x32x16_bf16 v[156:171], v[72:75], v[64:67], v[156:171]
    s_barrier
    ds_read_b128 v[60:63], v15 offset:32768
    ds_read_b128 v[64:67], v15 offset:36864
    ds_read_b64_tr_b16 v[68:69], v23 offset:0
    ds_read_b64_tr_b16 v[70:71], v23 offset:1024
    ds_read_b64_tr_b16 v[72:73], v23 offset:16384
    ds_read_b64_tr_b16 v[74:75], v23 offset:17408
    s_waitcnt lgkmcnt(6)
    v_mfma_f32_32x32x16_bf16 v[108:123], v[44:47], v[52:55], v[108:123]
    s_add_u32 m0, s45, 16384
    s_nop 0
    buffer_load_dwordx4 v8, s[84:87], s47 offen lds
    v_mfma_f32_32x32x16_bf16 v[124:139], v[48:51], v[52:55], v[124:139]
    v_mfma_f32_32x32x16_bf16 v[140:155], v[56:59], v[44:47], v[140:155]
    s_add_u32 m0, s45, 17408
    s_nop 0
    buffer_load_dwordx4 v9, s[84:87], s47 offen lds
    v_mfma_f32_32x32x16_bf16 v[156:171], v[56:59], v[48:51], v[156:171]
    ds_read_b128 v[44:47], v16 offset:32768
    ds_read_b128 v[48:51], v16 offset:36864
    ds_read_b64_tr_b16 v[52:53], v24 offset:0
    ds_read_b64_tr_b16 v[54:55], v24 offset:1024
    ds_read_b64_tr_b16 v[56:57], v24 offset:16384
    ds_read_b64_tr_b16 v[58:59], v24 offset:17408
    s_waitcnt lgkmcnt(6)
    v_mfma_f32_32x32x16_bf16 v[108:123], v[60:63], v[68:71], v[108:123]
    s_add_u32 m0, s46, 32768
    s_nop 0
    buffer_load_dwordx4 v10, s[12:15], s48 offen lds
    v_mfma_f32_32x32x16_bf16 v[124:139], v[64:67], v[68:71], v[124:139]
    v_mfma_f32_32x32x16_bf16 v[140:155], v[72:75], v[60:63], v[140:155]
    s_add_u32 m0, s46, 33792
    s_nop 0
    buffer_load_dwordx4 v11, s[12:15], s48 offen lds
    v_mfma_f32_32x32x16_bf16 v[156:171], v[72:75], v[64:67], v[156:171]
    s_waitcnt vmcnt(4)
    s_barrier
    ds_read_b128 v[60:63], v17 offset:32768
    ds_read_b128 v[64:67], v17 offset:36864
    ds_read_b64_tr_b16 v[68:69], v25 offset:0
    ds_read_b64_tr_b16 v[70:71], v25 offset:1024
    ds_read_b64_tr_b16 v[72:73], v25 offset:16384
    ds_read_b64_tr_b16 v[74:75], v25 offset:17408
    s_waitcnt lgkmcnt(6)
    v_mfma_f32_32x32x16_bf16 v[108:123], v[44:47], v[52:55], v[108:123]
    s_add_u32 m0, s46, 34816
    s_nop 0
    buffer_load_dwordx4 v12, s[12:15], s48 offen lds
    v_mfma_f32_32x32x16_bf16 v[124:139], v[48:51], v[52:55], v[124:139]
    s_add_u32 m0, s46, 35840
    s_nop 0
    buffer_load_dwordx4 v13, s[12:15], s48 offen lds
    s_add_u32 s47, s47, 128
    s_add_u32 s48, s48, s49
    s_add_u32 s69, s69, 1
    s_cmp_eq_u32 s69, 10
    s_cselect_b32 s47, 0, s47
    s_cselect_b32 s48, 0, s48
    s_cselect_b32 s69, 0, s69
    v_mfma_f32_32x32x16_bf16 v[140:155], v[56:59], v[44:47], v[140:155]
    v_mfma_f32_32x32x16_bf16 v[156:171], v[56:59], v[48:51], v[156:171]
    ds_read_b128 v[44:47], v14 offset:0
    ds_read_b128 v[48:51], v14 offset:4096
    ds_read_b64_tr_b16 v[52:53], v18 offset:0
    ds_read_b64_tr_b16 v[54:55], v18 offset:1024
    ds_read_b64_tr_b16 v[56:57], v18 offset:16384
    ds_read_b64_tr_b16 v[58:59], v18 offset:17408
    s_waitcnt lgkmcnt(6)
    v_mfma_f32_32x32x16_bf16 v[108:123], v[60:63], v[68:71], v[108:123]
    v_mfma_f32_32x32x16_bf16 v[124:139], v[64:67], v[68:71], v[124:139]
    v_mfma_f32_32x32x16_bf16 v[140:155], v[72:75], v[60:63], v[140:155]
    v_mfma_f32_32x32x16_bf16 v[156:171], v[72:75], v[64:67], v[156:171]
    s_barrier
    ds_read_b128 v[60:63], v15 offset:0
    ds_read_b128 v[64:67], v15 offset:4096
    ds_read_b64_tr_b16 v[68:69], v19 offset:0
    ds_read_b64_tr_b16 v[70:71], v19 offset:1024
    ds_read_b64_tr_b16 v[72:73], v19 offset:16384
    ds_read_b64_tr_b16 v[74:75], v19 offset:17408
    s_waitcnt lgkmcnt(6)
    v_mfma_f32_32x32x16_bf16 v[108:123], v[44:47], v[52:55], v[108:123]
    s_add_u32 m0, s45, 32768
    s_nop 0
    buffer_load_dwordx4 v8, s[84:87], s47 offen lds
    v_mfma_f32_32x32x16_bf16 v[124:139], v[48:51], v[52:55], v[124:139]
    v_mfma_f32_32x32x16_bf16 v[140:155], v[56:59], v[44:47], v[140:155]
    s_add_u32 m0, s45, 33792
    s_nop 0
    buffer_load_dwordx4 v9, s[84:87], s47 offen lds
    v_mfma_f32_32x32x16_bf16 v[156:171], v[56:59], v[48:51], v[156:171]
    ds_read_b128 v[44:47], v16 offset:0
    ds_read_b128 v[48:51], v16 offset:4096
    ds_read_b64_tr_b16 v[52:53], v20 offset:0
    ds_read_b64_tr_b16 v[54:55], v20 offset:1024
    ds_read_b64_tr_b16 v[56:57], v20 offset:16384
    ds_read_b64_tr_b16 v[58:59], v20 offset:17408
    s_waitcnt lgkmcnt(6)
    v_mfma_f32_32x32x16_bf16 v[108:123], v[60:63], v[68:71], v[108:123]
    s_add_u32 m0, s46, 65536
    s_nop 0
    buffer_load_dwordx4 v10, s[12:15], s48 offen lds
    v_mfma_f32_32x32x16_bf16 v[124:139], v[64:67], v[68:71], v[124:139]
    v_mfma_f32_32x32x16_bf16 v[140:155], v[72:75], v[60:63], v[140:155]
    s_add_u32 m0, s46, 66560
    s_nop 0
    buffer_load_dwordx4 v11, s[12:15], s48 offen lds
    v_mfma_f32_32x32x16_bf16 v[156:171], v[72:75], v[64:67], v[156:171]
    s_waitcnt vmcnt(4)
    s_barrier
    ds_read_b128 v[60:63], v17 offset:0
    ds_read_b128 v[64:67], v17 offset:4096
    ds_read_b64_tr_b16 v[68:69], v21 offset:0
    ds_read_b64_tr_b16 v[70:71], v21 offset:1024
    ds_read_b64_tr_b16 v[72:73], v21 offset:16384
    ds_read_b64_tr_b16 v[74:75], v21 offset:17408
    s_waitcnt lgkmcnt(6)
    v_mfma_f32_32x32x16_bf16 v[108:123], v[44:47], v[52:55], v[108:123]
    s_add_u32 m0, s46, 67584
    s_nop 0
    buffer_load_dwordx4 v12, s[12:15], s48 offen lds
    v_mfma_f32_32x32x16_bf16 v[124:139], v[48:51], v[52:55], v[124:139]
    s_add_u32 m0, s46, 68608
    s_nop 0
    buffer_load_dwordx4 v13, s[12:15], s48 offen lds
    s_add_u32 s47, s47, 128
    s_add_u32 s48, s48, s49
    s_add_u32 s69, s69, 1
    s_cmp_eq_u32 s69, 10
    s_cselect_b32 s47, 0, s47
    s_cselect_b32 s48, 0, s48
    s_cselect_b32 s69, 0, s69
    v_mfma_f32_32x32x16_bf16 v[140:155], v[56:59], v[44:47], v[140:155]
    v_mfma_f32_32x32x16_bf16 v[156:171], v[56:59], v[48:51], v[156:171]
    ds_read_b128 v[44:47], v14 offset:16384
    ds_read_b128 v[48:51], v14 offset:20480
    ds_read_b64_tr_b16 v[52:53], v18 offset:32768
    ds_read_b64_tr_b16 v[54:55], v18 offset:33792
    ds_read_b64_tr_b16 v[56:57], v18 offset:49152
    ds_read_b64_tr_b16 v[58:59], v18 offset:50176
    s_waitcnt lgkmcnt(6)
    v_mfma_f32_32x32x16_bf16 v[108:123], v[60:63], v[68:71], v[108:123]
    v_mfma_f32_32x32x16_bf16 v[124:139], v[64:67], v[68:71], v[124:139]
    v_mfma_f32_32x32x16_bf16 v[140:155], v[72:75], v[60:63], v[140:155]
    v_mfma_f32_32x32x16_bf16 v[156:171], v[72:75], v[64:67], v[156:171]
    s_barrier
    ds_read_b128 v[60:63], v15 offset:16384
    ds_read_b128 v[64:67], v15 offset:20480
    ds_read_b64_tr_b16 v[68:69], v19 offset:32768
    ds_read_b64_tr_b16 v[70:71], v19 offset:33792
    ds_read_b64_tr_b16 v[72:73], v19 offset:49152
    ds_read_b64_tr_b16 v[74:75], v19 offset:50176
    s_waitcnt lgkmcnt(6)
    v_mfma_f32_32x32x16_bf16 v[108:123], v[44:47], v[52:55], v[108:123]
    s_add_u32 m0, s45, 0
    s_nop 0
    buffer_load_dwordx4 v8, s[84:87], s47 offen lds
    v_mfma_f32_32x32x16_bf16 v[124:139], v[48:51], v[52:55], v[124:139]
    v_mfma_f32_32x32x16_bf16 v[140:155], v[56:59], v[44:47], v[140:155]
    s_add_u32 m0, s45, 1024
    s_nop 0
    buffer_load_dwordx4 v9, s[84:87], s47 offen lds
    v_mfma_f32_32x32x16_bf16 v[156:171], v[56:59], v[48:51], v[156:171]
    ds_read_b128 v[44:47], v16 offset:16384
    ds_read_b128 v[48:51], v16 offset:20480
    ds_read_b64_tr_b16 v[52:53], v20 offset:32768
    ds_read_b64_tr_b16 v[54:55], v20 offset:33792
    ds_read_b64_tr_b16 v[56:57], v20 offset:49152
    ds_read_b64_tr_b16 v[58:59], v20 offset:50176
    s_waitcnt lgkmcnt(6)
    v_mfma_f32_32x32x16_bf16 v[108:123], v[60:63], v[68:71], v[108:123]
    s_add_u32 m0, s46, 0
    s_nop 0
    buffer_load_dwordx4 v10, s[12:15], s48 offen lds
    v_mfma_f32_32x32x16_bf16 v[124:139], v[64:67], v[68:71], v[124:139]
    v_mfma_f32_32x32x16_bf16 v[140:155], v[72:75], v[60:63], v[140:155]
    s_add_u32 m0, s46, 1024
    s_nop 0
    buffer_load_dwordx4 v11, s[12:15], s48 offen lds
    v_mfma_f32_32x32x16_bf16 v[156:171], v[72:75], v[64:67], v[156:171]
    s_waitcnt vmcnt(4)
    s_barrier
    ds_read_b128 v[60:63], v17 offset:16384
    ds_read_b128 v[64:67], v17 offset:20480
    ds_read_b64_tr_b16 v[68:69], v21 offset:32768
    ds_read_b64_tr_b16 v[70:71], v21 offset:33792
    ds_read_b64_tr_b16 v[72:73], v21 offset:49152
    ds_read_b64_tr_b16 v[74:75], v21 offset:50176
    s_waitcnt lgkmcnt(6)
    v_mfma_f32_32x32x16_bf16 v[108:123], v[44:47], v[52:55], v[108:123]
    s_add_u32 m0, s46, 2048
    s_nop 0
    buffer_load_dwordx4 v12, s[12:15], s48 offen lds
    v_mfma_f32_32x32x16_bf16 v[124:139], v[48:51], v[52:55], v[124:139]
    s_add_u32 m0, s46, 3072
    s_nop 0
    buffer_load_dwordx4 v13, s[12:15], s48 offen lds
    s_add_u32 s47, s47, 128
    s_add_u32 s48, s48, s49
    s_add_u32 s69, s69, 1
    s_cmp_eq_u32 s69, 10
    s_cselect_b32 s47, 0, s47
    s_cselect_b32 s48, 0, s48
    s_cselect_b32 s69, 0, s69
    v_mfma_f32_32x32x16_bf16 v[140:155], v[56:59], v[44:47], v[140:155]
    v_mfma_f32_32x32x16_bf16 v[156:171], v[56:59], v[48:51], v[156:171]
    ds_read_b128 v[44:47], v14 offset:32768
    ds_read_b128 v[48:51], v14 offset:36864
    ds_read_b64_tr_b16 v[52:53], v22 offset:0
    ds_read_b64_tr_b16 v[54:55], v22 offset:1024
    ds_read_b64_tr_b16 v[56:57], v22 offset:16384
    ds_read_b64_tr_b16 v[58:59], v22 offset:17408
    s_waitcnt lgkmcnt(6)
    v_mfma_f32_32x32x16_bf16 v[108:123], v[60:63], v[68:71], v[108:123]
    buffer_load_dwordx3 v[76:78], v40, s[16:19], 0 offen offset:0 sc0 sc1
    buffer_load_dwordx3 v[80:82], v40, s[16:19], 0 offen offset:2048 sc0 sc1
    v_mfma_f32_32x32x16_bf16 v[124:139], v[64:67], v[68:71], v[124:139]
    buffer_load_dwordx3 v[84:86], v40, s[16:19], s89 offen offset:0 sc0 sc1
    buffer_load_dwordx3 v[88:90], v40, s[16:19], s89 offen offset:2048 sc0 sc1
    v_mfma_f32_32x32x16_bf16 v[140:155], v[72:75], v[60:63], v[140:155]
    buffer_load_dwordx3 v[92:94], v40, s[16:19], s90 offen offset:0 sc0 sc1
    buffer_load_dwordx3 v[96:98], v40, s[16:19], 0 offen offset:512 sc0 sc1
    v_mfma_f32_32x32x16_bf16 v[156:171], v[72:75], v[64:67], v[156:171]
    buffer_load_dwordx3 v[100:102], v40, s[16:19], 0 offen offset:2560 sc0 sc1
    buffer_load_dwordx3 v[104:106], v40, s[16:19], s89 offen offset:512 sc0 sc1
    ds_read_b128 v[60:63], v15 offset:32768
    ds_read_b128 v[64:67], v15 offset:36864
    ds_read_b64_tr_b16 v[68:69], v23 offset:0
    ds_read_b64_tr_b16 v[70:71], v23 offset:1024
    ds_read_b64_tr_b16 v[72:73], v23 offset:16384
    ds_read_b64_tr_b16 v[74:75], v23 offset:17408
    s_waitcnt lgkmcnt(6)
    v_mfma_f32_32x32x16_bf16 v[108:123], v[44:47], v[52:55], v[108:123]
    buffer_load_dwordx3 v[192:194], v40, s[16:19], s89 offen offset:2560 sc0 sc1
    buffer_load_dwordx3 v[196:198], v40, s[16:19], s90 offen offset:512 sc0 sc1
    v_mfma_f32_32x32x16_bf16 v[124:139], v[48:51], v[52:55], v[124:139]
    buffer_load_dwordx2 v[172:173], v41, s[16:19], 0 offen offset:0 sc0 sc1
    buffer_load_dwordx2 v[174:175], v41, s[16:19], 0 offen offset:2048 sc0 sc1
    v_mfma_f32_32x32x16_bf16 v[140:155], v[56:59], v[44:47], v[140:155]
    buffer_load_dwordx2 v[176:177], v41, s[16:19], s89 offen offset:0 sc0 sc1
    buffer_load_dwordx2 v[178:179], v41, s[16:19], s89 offen offset:2048 sc0 sc1
    v_mfma_f32_32x32x16_bf16 v[156:171], v[56:59], v[48:51], v[156:171]
    buffer_load_dwordx2 v[180:181], v41, s[16:19], s90 offen offset:0 sc0 sc1
    buffer_load_dwordx2 v[182:183], v41, s[16:19], 0 offen offset:1024 sc0 sc1
    ds_read_b128 v[44:47], v16 offset:32768
    ds_read_b128 v[48:51], v16 offset:36864
    ds_read_b64_tr_b16 v[52:53], v24 offset:0
    ds_read_b64_tr_b16 v[54:55], v24 offset:1024
    ds_read_b64_tr_b16 v[56:57], v24 offset:16384
    ds_read_b64_tr_b16 v[58:59], v24 offset:17408
    s_waitcnt lgkmcnt(6)
    v_mfma_f32_32x32x16_bf16 v[108:123], v[60:63], v[68:71], v[108:123]
    buffer_load_dwordx2 v[184:185], v41, s[16:19], 0 offen offset:3072 sc0 sc1
    buffer_load_dwordx2 v[186:187], v41, s[16:19], s89 offen offset:1024 sc0 sc1
    v_mfma_f32_32x32x16_bf16 v[124:139], v[64:67], v[68:71], v[124:139]
    buffer_load_dwordx2 v[188:189], v41, s[16:19], s89 offen offset:3072 sc0 sc1
    buffer_load_dwordx2 v[190:191], v41, s[16:19], s90 offen offset:1024 sc0 sc1
    v_mfma_f32_32x32x16_bf16 v[140:155], v[72:75], v[60:63], v[140:155]
    v_mfma_f32_32x32x16_bf16 v[156:171], v[72:75], v[64:67], v[156:171]
    s_waitcnt vmcnt(20)
    s_barrier
    ds_read_b128 v[60:63], v17 offset:32768
    ds_read_b128 v[64:67], v17 offset:36864
    ds_read_b64_tr_b16 v[68:69], v25 offset:0
    ds_read_b64_tr_b16 v[70:71], v25 offset:1024
    ds_read_b64_tr_b16 v[72:73], v25 offset:16384
    ds_read_b64_tr_b16 v[74:75], v25 offset:17408
    s_waitcnt lgkmcnt(6)
    v_mfma_f32_32x32x16_bf16 v[108:123], v[44:47], v[52:55], v[108:123]
    v_mfma_f32_32x32x16_bf16 v[124:139], v[48:51], v[52:55], v[124:139]
    v_mfma_f32_32x32x16_bf16 v[140:155], v[56:59], v[44:47], v[140:155]
    v_mfma_f32_32x32x16_bf16 v[156:171], v[56:59], v[48:51], v[156:171]
    ds_read_b128 v[44:47], v14 offset:0
    ds_read_b128 v[48:51], v14 offset:4096
    ds_read_b64_tr_b16 v[52:53], v18 offset:0
    ds_read_b64_tr_b16 v[54:55], v18 offset:1024
    ds_read_b64_tr_b16 v[56:57], v18 offset:16384
    ds_read_b64_tr_b16 v[58:59], v18 offset:17408
    s_waitcnt lgkmcnt(6)
    v_mfma_f32_32x32x16_bf16 v[108:123], v[60:63], v[68:71], v[108:123]
    v_mfma_f32_32x32x16_bf16 v[124:139], v[64:67], v[68:71], v[124:139]
    v_mfma_f32_32x32x16_bf16 v[140:155], v[72:75], v[60:63], v[140:155]
    v_mfma_f32_32x32x16_bf16 v[156:171], v[72:75], v[64:67], v[156:171]
    s_waitcnt vmcnt(0)
    ds_read_b128 v[60:63], v15 offset:0
    ds_read_b128 v[64:67], v15 offset:4096
    ds_read_b64_tr_b16 v[68:69], v19 offset:0
    ds_read_b64_tr_b16 v[70:71], v19 offset:1024
    ds_read_b64_tr_b16 v[72:73], v19 offset:16384
    ds_read_b64_tr_b16 v[74:75], v19 offset:17408
    s_waitcnt lgkmcnt(6)
    v_mfma_f32_32x32x16_bf16 v[108:123], v[44:47], v[52:55], v[108:123]
    v_subrev_u32 v78, s88, v78
    v_subrev_u32 v82, s88, v82
    v_subrev_u32 v86, s88, v86
    v_subrev_u32 v90, s88, v90
    v_subrev_u32 v94, s88, v94
    v_subrev_u32 v98, s88, v98
    v_subrev_u32 v102, s88, v102
    v_subrev_u32 v106, s88, v106
    v_subrev_u32 v194, s88, v194
    v_subrev_u32 v198, s88, v198
    v_subrev_u32 v173, s88, v173
    v_subrev_u32 v175, s88, v175
    v_mfma_f32_32x32x16_bf16 v[124:139], v[48:51], v[52:55], v[124:139]
    v_subrev_u32 v177, s88, v177
    v_subrev_u32 v179, s88, v179
    v_subrev_u32 v181, s88, v181
    v_subrev_u32 v183, s88, v183
    v_subrev_u32 v185, s88, v185
    v_subrev_u32 v187, s88, v187
    v_subrev_u32 v189, s88, v189
    v_subrev_u32 v191, s88, v191
    v_max3_u32 v206, v78, v82, v86
    v_max3_u32 v206, v206, v90, v94
    v_max3_u32 v206, v206, v98, v102
    v_max3_u32 v206, v206, v106, v194
    v_mfma_f32_32x32x16_bf16 v[140:155], v[56:59], v[44:47], v[140:155]
    v_max3_u32 v206, v206, v198, v173
    v_max3_u32 v206, v206, v175, v177
    v_max3_u32 v206, v206, v179, v181
    v_max3_u32 v206, v206, v183, v185
    v_max3_u32 v206, v206, v187, v189
    v_max_u32 v206, v206, v191
    v_cmp_gt_u32 vcc, 4700, v206
    s_cmp_eq_u64 vcc, -1
    s_cselect_b32 s92, 1, 0
    v_add_f32 v208, v76, v80
    v_add_f32 v209, v77, v81
    v_add_f32 v84, v84, v88
    v_mfma_f32_32x32x16_bf16 v[156:171], v[56:59], v[48:51], v[156:171]
    v_add_f32 v85, v85, v89
    v_add_f32 v208, v208, v92
    v_add_f32 v209, v209, v93
    v_add_f32 v208, v208, v84
    v_add_f32 v209, v209, v85
    v_add_f32 v224, v96, v100
    v_add_f32 v225, v97, v101
    v_add_f32 v104, v104, v192
    v_add_f32 v105, v105, v193
    v_add_f32 v224, v224, v196
    v_add_f32 v225, v225, v197
    v_add_f32 v224, v224, v104
    ds_read_b128 v[44:47], v16 offset:0
    ds_read_b128 v[48:51], v16 offset:4096
    ds_read_b64_tr_b16 v[52:53], v20 offset:0
    ds_read_b64_tr_b16 v[54:55], v20 offset:1024
    ds_read_b64_tr_b16 v[56:57], v20 offset:16384
    ds_read_b64_tr_b16 v[58:59], v20 offset:17408
    s_waitcnt lgkmcnt(6)
    v_mfma_f32_32x32x16_bf16 v[108:123], v[60:63], v[68:71], v[108:123]
    v_add_f32 v225, v225, v105
    v_add_f32 v240, v172, v174
    v_add_f32 v176, v176, v178
    v_add_f32 v240, v240, v180
    v_add_f32 v240, v240, v176
    v_add_f32 v241, v182, v184
    v_add_f32 v186, v186, v188
    v_add_f32 v241, v241, v190
    v_add_f32 v241, v241, v186
    s_nop 2
    v_mov_b32 v200, v208
    v_mov_b32 v201, v209
    v_mfma_f32_32x32x16_bf16 v[124:139], v[64:67], v[68:71], v[124:139]
    v_mov_b32 v202, v224
    v_mov_b32 v203, v225
    v_mov_b32 v204, v240
    v_mov_b32 v205, v241
    s_nop 1
    v_permlane32_swap_b32 v208, v200
    v_permlane32_swap_b32 v209, v201
    v_permlane32_swap_b32 v224, v202
    v_permlane32_swap_b32 v225, v203
    v_permlane32_swap_b32 v240, v204
    v_permlane32_swap_b32 v241, v205
    s_nop 1
    v_mfma_f32_32x32x16_bf16 v[140:155], v[72:75], v[60:63], v[140:155]
    v_add_f32 v208, v208, v200
    v_add_f32 v209, v209, v201
    v_add_f32 v224, v224, v202
    v_add_f32 v225, v225, v203
    v_add_f32 v240, v240, v204
    v_add_f32 v241, v241, v205
    v_mul_f32 v208, s64, v208
    v_mul_f32 v224, s64, v224
    v_mul_f32 v209, s64, v209
    v_mul_f32 v225, s64, v225
    v_fma_f32 v209, -v208, v208, v209
    v_fma_f32 v225, -v224, v224, v225
    v_mfma_f32_32x32x16_bf16 v[156:171], v[72:75], v[64:67], v[156:171]
    v_max_f32 v209, 0, v209
    v_max_f32 v225, 0, v225
    v_cvt_pk_bf16_f32 v210, v208, v208
    v_cvt_pk_bf16_f32 v226, v224, v224
    v_cvt_pk_bf16_f32 v211, v209, v209
    v_cvt_pk_bf16_f32 v227, v225, v225
    v_lshlrev_b32 v210, 16, v210
    v_lshlrev_b32 v226, 16, v226
    v_lshlrev_b32 v211, 16, v211
    v_lshlrev_b32 v227, 16, v227
    v_add_f32 v211, s65, v211
    v_add_f32 v227, s65, v227
    ds_read_b128 v[60:63], v17 offset:0
    ds_read_b128 v[64:67], v17 offset:4096
    ds_read_b64_tr_b16 v[68:69], v21 offset:0
    ds_read_b64_tr_b16 v[70:71], v21 offset:1024
    ds_read_b64_tr_b16 v[72:73], v21 offset:16384
    ds_read_b64_tr_b16 v[74:75], v21 offset:17408
    s_waitcnt lgkmcnt(6)
    v_mfma_f32_32x32x16_bf16 v[108:123], v[44:47], v[52:55], v[108:123]
    v_cvt_pk_bf16_f32 v211, v211, v211
    v_cvt_pk_bf16_f32 v227, v227, v227
    v_lshlrev_b32 v211, 16, v211
    v_lshlrev_b32 v227, 16, v227
    v_sqrt_f32 v211, v211
    v_sqrt_f32 v227, v227
    v_cvt_pk_bf16_f32 v211, v211, v211
    v_cvt_pk_bf16_f32 v227, v227, v227
    v_lshlrev_b32 v211, 16, v211
    v_lshlrev_b32 v227, 16, v227
    v_rcp_f32 v212, v211
    v_rcp_f32 v228, v227
    v_mfma_f32_32x32x16_bf16 v[124:139], v[48:51], v[52:55], v[124:139]
    v_sub_f32 v214, v208, v210
    v_sub_f32 v230, v224, v226
    v_fma_f32 v213, -v211, v212, 1.0
    v_fma_f32 v229, -v227, v228, 1.0
    v_fma_f32 v212, v212, v213, v212
    v_fma_f32 v228, v228, v229, v228
    v_mul_f32 v213, v210, v212
    v_mul_f32 v229, v226, v228
    v_mul_f32 v214, v214, v212
    v_mul_f32 v230, v230, v228
    v_mul_f32 v215, v209, v212
    v_mul_f32 v231, v225, v228
    v_mfma_f32_32x32x16_bf16 v[140:155], v[56:59], v[44:47], v[140:155]
    v_cvt_pk_bf16_f32 v214, v214, v214
    v_cvt_pk_bf16_f32 v230, v230, v230
    v_mul_f32 v215, v215, v212
    v_mul_f32 v231, v231, v228
    v_lshlrev_b32 v214, 16, v214
    v_lshlrev_b32 v230, 16, v230
    v_cvt_pk_bf16_f32 v215, v215, v215
    v_cvt_pk_bf16_f32 v231, v231, v231
    v_lshlrev_b32 v215, 16, v215
    v_lshlrev_b32 v231, 16, v231
    v_add_f32 v215, s65, v215
    v_add_f32 v231, s65, v231
    v_mfma_f32_32x32x16_bf16 v[156:171], v[56:59], v[48:51], v[156:171]
    v_cvt_pk_bf16_f32 v215, v215, v215
    v_cvt_pk_bf16_f32 v231, v231, v231
    v_lshlrev_b32 v215, 16, v215
    v_lshlrev_b32 v231, 16, v231
    v_sqrt_f32 v215, v215
    v_sqrt_f32 v231, v231
    v_cvt_pk_bf16_f32 v215, v215, v215
    v_cvt_pk_bf16_f32 v231, v231, v231
    v_lshlrev_b32 v215, 16, v215
    v_lshlrev_b32 v231, 16, v231
    v_rcp_f32 v216, v215
    v_rcp_f32 v232, v231
    s_waitcnt lgkmcnt(0)
    v_mfma_f32_32x32x16_bf16 v[108:123], v[60:63], v[68:71], v[108:123]
    v_mul_f32 v244, s66, v212
    v_mul_f32 v245, s66, v228
    v_fma_f32 v217, -v215, v216, 1.0
    v_fma_f32 v233, -v231, v232, 1.0
    v_fma_f32 v216, v216, v217, v216
    v_fma_f32 v232, v232, v233, v232
    v_mul_f32 v246, s66, v213
    v_mul_f32 v247, s66, v229
    v_sub_f32 v246, 0, v246
    v_sub_f32 v247, 0, v247
    v_mul_f32 v248, v212, v216
    v_mul_f32 v249, v228, v232
    v_mfma_f32_32x32x16_bf16 v[124:139], v[64:67], v[68:71], v[124:139]
    v_add_f32 v219, v213, v214
    v_add_f32 v235, v229, v230
    v_mul_f32 v219, v219, v216
    v_mul_f32 v235, v235, v232
    v_sub_f32 v250, 0, v219
    v_sub_f32 v251, 0, v235
    v_lshlrev_b32 v243, 16, v242
    ds_write_b32 v42, v240
    ds_write_b32 v42, v241 offset:128
    ds_write_b32 v42, v243 offset:256
    ds_write_b32 v42, v244 offset:384
    ds_write_b32 v42, v245 offset:512
    v_mfma_f32_32x32x16_bf16 v[140:155], v[72:75], v[60:63], v[140:155]
    ds_write_b32 v42, v246 offset:640
    ds_write_b32 v42, v247 offset:768
    v_mfma_f32_32x32x16_bf16 v[156:171], v[72:75], v[64:67], v[156:171]
K1_EPI:
    s_mov_b32 s57, 0
    s_cmp_eq_u32 s92, 1
    s_cbranch_scc1 K1_READY
K1_POLL:
    buffer_load_dwordx3 v[76:78], v40, s[16:19], 0 offen offset:0 sc0 sc1
    buffer_load_dwordx3 v[80:82], v40, s[16:19], 0 offen offset:2048 sc0 sc1
    buffer_load_dwordx3 v[84:86], v40, s[16:19], s89 offen offset:0 sc0 sc1
    buffer_load_dwordx3 v[88:90], v40, s[16:19], s89 offen offset:2048 sc0 sc1
    buffer_load_dwordx3 v[92:94], v40, s[16:19], s90 offen offset:0 sc0 sc1
    buffer_load_dwordx3 v[96:98], v40, s[16:19], 0 offen offset:512 sc0 sc1
    buffer_load_dwordx3 v[100:102], v40, s[16:19], 0 offen offset:2560 sc0 sc1
    buffer_load_dwordx3 v[104:106], v40, s[16:19], s89 offen offset:512 sc0 sc1
    buffer_load_dwordx3 v[192:194], v40, s[16:19], s89 offen offset:2560 sc0 sc1
    buffer_load_dwordx3 v[196:198], v40, s[16:19], s90 offen offset:512 sc0 sc1
    buffer_load_dwordx2 v[172:173], v41, s[16:19], 0 offen offset:0 sc0 sc1
    buffer_load_dwordx2 v[174:175], v41, s[16:19], 0 offen offset:2048 sc0 sc1
    buffer_load_dwordx2 v[176:177], v41, s[16:19], s89 offen offset:0 sc0 sc1
    buffer_load_dwordx2 v[178:179], v41, s[16:19], s89 offen offset:2048 sc0 sc1
    buffer_load_dwordx2 v[180:181], v41, s[16:19], s90 offen offset:0 sc0 sc1
    buffer_load_dwordx2 v[182:183], v41, s[16:19], 0 offen offset:1024 sc0 sc1
    buffer_load_dwordx2 v[184:185], v41, s[16:19], 0 offen offset:3072 sc0 sc1
    buffer_load_dwordx2 v[186:187], v41, s[16:19], s89 offen offset:1024 sc0 sc1
    buffer_load_dwordx2 v[188:189], v41, s[16:19], s89 offen offset:3072 sc0 sc1
    buffer_load_dwordx2 v[190:191], v41, s[16:19], s90 offen offset:1024 sc0 sc1
    s_waitcnt vmcnt(0)
    v_subrev_u32 v78, s88, v78
    v_subrev_u32 v82, s88, v82
    v_subrev_u32 v86, s88, v86
    v_subrev_u32 v90, s88, v90
    v_subrev_u32 v94, s88, v94
    v_subrev_u32 v98, s88, v98
    v_subrev_u32 v102, s88, v102
    v_subrev_u32 v106, s88, v106
    v_subrev_u32 v194, s88, v194
    v_subrev_u32 v198, s88, v198
    v_subrev_u32 v173, s88, v173
    v_subrev_u32 v175, s88, v175
    v_subrev_u32 v177, s88, v177
    v_subrev_u32 v179, s88, v179
    v_subrev_u32 v181, s88, v181
    v_subrev_u32 v183, s88, v183
    v_subrev_u32 v185, s88, v185
    v_subrev_u32 v187, s88, v187
    v_subrev_u32 v189, s88, v189
    v_subrev_u32 v191, s88, v191
    v_max3_u32 v206, v78, v82, v86
    v_max3_u32 v206, v206, v90, v94
    v_max3_u32 v206, v206, v98, v102
    v_max3_u32 v206, v206, v106, v194
    v_max3_u32 v206, v206, v198, v173
    v_max3_u32 v206, v206, v175, v177
    v_max3_u32 v206, v206, v179, v181
    v_max3_u32 v206, v206, v183, v185
    v_max3_u32 v206, v206, v187, v189
    v_max_u32 v206, v206, v191
    v_cmp_gt_u32 vcc, 4700, v206
    s_cmp_eq_u64 vcc, -1
    s_cselect_b32 s92, 1, 0
    s_cmp_eq_u32 s92, 1
    s_cbranch_scc1 K1_GOT
    s_add_u32 s57, s57, 1
    s_cmp_lt_u32 s57, 32
    s_cbranch_scc1 K1_POLL
    s_lshl_b32 s55, s36, 7
    s_lshl_b32 s56, s39, 6
    s_add_u32 s55, s55, s56
    v_add_u32 v4, s55, v2
    v_mul_u32_u24 v4, 1280, v4
    v_lshl_add_u32 v4, v3, 4, v4
    v_add_u32 v5, 40960, v4
    v_mov_b32 v6, 0x3f803f80
    v_mov_b32 v208, 0
    v_mov_b32 v209, 0
    v_mov_b32 v224, 0
    v_mov_b32 v225, 0
    s_mov_b32 s55, 0
K1_SLOWR:
    buffer_load_dwordx4 v[212:215], v4, s[84:87], s55 offen
    buffer_load_dwordx4 v[228:231], v5, s[84:87], s55 offen
    s_waitcnt vmcnt(0)
    v_dot2_f32_bf16 v208, v212, v6, v208
    v_dot2_f32_bf16 v209, v212, v212, v209
    v_dot2_f32_bf16 v208, v213, v6, v208
    v_dot2_f32_bf16 v209, v213, v213, v209
    v_dot2_f32_bf16 v208, v214, v6, v208
    v_dot2_f32_bf16 v209, v214, v214, v209
    v_dot2_f32_bf16 v208, v215, v6, v208
    v_dot2_f32_bf16 v209, v215, v215, v209
    v_dot2_f32_bf16 v224, v228, v6, v224
    v_dot2_f32_bf16 v225, v228, v228, v225
    v_dot2_f32_bf16 v224, v229, v6, v224
    v_dot2_f32_bf16 v225, v229, v229, v225
    v_dot2_f32_bf16 v224, v230, v6, v224
    v_dot2_f32_bf16 v225, v230, v230, v225
    v_dot2_f32_bf16 v224, v231, v6, v224
    v_dot2_f32_bf16 v225, v231, v231, v225
    s_add_u32 s55, s55, 32
    s_cmp_lt_u32 s55, 1280
    s_cbranch_scc1 K1_SLOWR
    v_add_u32 v6, s50, v2
    v_mul_u32_u24 v4, 3840, v3
    v_lshl_add_u32 v4, v6, 1, v4
    v_mul_u32_u24 v5, 3456, v3
    v_lshl_add_u32 v5, v6, 1, v5
    v_mov_b32 v240, 0
    v_mov_b32 v241, 0
    s_mov_b32 s55, 0
    s_mov_b32 s56, 0
    s_mov_b32 s58, 0
K1_SLOWC:
    buffer_load_ushort v200, v4, s[8:11], s55 offen
    buffer_load_ushort v201, v5, s[80:83], s58 offen
    s_waitcnt vmcnt(0)
    v_lshlrev_b32 v200, 16, v200
    v_lshlrev_b32 v201, 16, v201
    v_add_f32 v240, v240, v200
    v_add_f32 v241, v241, v201
    s_add_u32 s55, s55, 7680
    s_add_u32 s58, s58, 6912
    s_add_u32 s56, s56, 1
    s_cmp_lt_u32 s56, 320
    s_cbranch_scc1 K1_SLOWC
    s_branch K1_SCAL
K1_GOT:
    v_add_f32 v208, v76, v80
    v_add_f32 v209, v77, v81
    v_add_f32 v84, v84, v88
    v_add_f32 v85, v85, v89
    v_add_f32 v208, v208, v92
    v_add_f32 v209, v209, v93
    v_add_f32 v208, v208, v84
    v_add_f32 v209, v209, v85
    v_add_f32 v224, v96, v100
    v_add_f32 v225, v97, v101
    v_add_f32 v104, v104, v192
    v_add_f32 v105, v105, v193
    v_add_f32 v224, v224, v196
    v_add_f32 v225, v225, v197
    v_add_f32 v224, v224, v104
    v_add_f32 v225, v225, v105
    v_add_f32 v240, v172, v174
    v_add_f32 v176, v176, v178
    v_add_f32 v240, v240, v180
    v_add_f32 v240, v240, v176
    v_add_f32 v241, v182, v184
    v_add_f32 v186, v186, v188
    v_add_f32 v241, v241, v190
    v_add_f32 v241, v241, v186
K1_SCAL:
    s_nop 2
    v_mov_b32 v200, v208
    v_mov_b32 v201, v209
    v_mov_b32 v202, v224
    v_mov_b32 v203, v225
    v_mov_b32 v204, v240
    v_mov_b32 v205, v241
    s_nop 1
    v_permlane32_swap_b32 v208, v200
    v_permlane32_swap_b32 v209, v201
    v_permlane32_swap_b32 v224, v202
    v_permlane32_swap_b32 v225, v203
    v_permlane32_swap_b32 v240, v204
    v_permlane32_swap_b32 v241, v205
    s_nop 1
    v_add_f32 v208, v208, v200
    v_add_f32 v209, v209, v201
    v_add_f32 v224, v224, v202
    v_add_f32 v225, v225, v203
    v_add_f32 v240, v240, v204
    v_add_f32 v241, v241, v205
    v_mul_f32 v208, s64, v208
    v_mul_f32 v224, s64, v224
    v_mul_f32 v209, s64, v209
    v_mul_f32 v225, s64, v225
    v_fma_f32 v209, -v208, v208, v209
    v_fma_f32 v225, -v224, v224, v225
    v_max_f32 v209, 0, v209
    v_max_f32 v225, 0, v225
    v_cvt_pk_bf16_f32 v210, v208, v208
    v_cvt_pk_bf16_f32 v226, v224, v224
    v_cvt_pk_bf16_f32 v211, v209, v209
    v_cvt_pk_bf16_f32 v227, v225, v225
    v_lshlrev_b32 v210, 16, v210
    v_lshlrev_b32 v226, 16, v226
    v_lshlrev_b32 v211, 16, v211
    v_lshlrev_b32 v227, 16, v227
    v_add_f32 v211, s65, v211
    v_add_f32 v227, s65, v227
    v_cvt_pk_bf16_f32 v211, v211, v211
    v_cvt_pk_bf16_f32 v227, v227, v227
    v_lshlrev_b32 v211, 16, v211
    v_lshlrev_b32 v227, 16, v227
    v_sqrt_f32 v211, v211
    v_sqrt_f32 v227, v227
    v_cvt_pk_bf16_f32 v211, v211, v211
    v_cvt_pk_bf16_f32 v227, v227, v227
    v_lshlrev_b32 v211, 16, v211
    v_lshlrev_b32 v227, 16, v227
    v_rcp_f32 v212, v211
    v_rcp_f32 v228, v227
    v_sub_f32 v214, v208, v210
    v_sub_f32 v230, v224, v226
    v_fma_f32 v213, -v211, v212, 1.0
    v_fma_f32 v229, -v227, v228, 1.0
    v_fma_f32 v212, v212, v213, v212
    v_fma_f32 v228, v228, v229, v228
    v_mul_f32 v213, v210, v212
    v_mul_f32 v229, v226, v228
    v_mul_f32 v214, v214, v212
    v_mul_f32 v230, v230, v228
    v_mul_f32 v215, v209, v212
    v_mul_f32 v231, v225, v228
    v_cvt_pk_bf16_f32 v214, v214, v214
    v_cvt_pk_bf16_f32 v230, v230, v230
    v_mul_f32 v215, v215, v212
    v_mul_f32 v231, v231, v228
    v_lshlrev_b32 v214, 16, v214
    v_lshlrev_b32 v230, 16, v230
    v_cvt_pk_bf16_f32 v215, v215, v215
    v_cvt_pk_bf16_f32 v231, v231, v231
    v_lshlrev_b32 v215, 16, v215
    v_lshlrev_b32 v231, 16, v231
    v_add_f32 v215, s65, v215
    v_add_f32 v231, s65, v231
    v_cvt_pk_bf16_f32 v215, v215, v215
    v_cvt_pk_bf16_f32 v231, v231, v231
    v_lshlrev_b32 v215, 16, v215
    v_lshlrev_b32 v231, 16, v231
    v_sqrt_f32 v215, v215
    v_sqrt_f32 v231, v231
    v_cvt_pk_bf16_f32 v215, v215, v215
    v_cvt_pk_bf16_f32 v231, v231, v231
    v_lshlrev_b32 v215, 16, v215
    v_lshlrev_b32 v231, 16, v231
    v_rcp_f32 v216, v215
    v_rcp_f32 v232, v231
    v_mul_f32 v244, s66, v212
    v_mul_f32 v245, s66, v228
    v_fma_f32 v217, -v215, v216, 1.0
    v_fma_f32 v233, -v231, v232, 1.0
    v_fma_f32 v216, v216, v217, v216
    v_fma_f32 v232, v232, v233, v232
    v_mul_f32 v246, s66, v213
    v_mul_f32 v247, s66, v229
    v_sub_f32 v246, 0, v246
    v_sub_f32 v247, 0, v247
    v_mul_f32 v248, v212, v216
    v_mul_f32 v249, v228, v232
    v_add_f32 v219, v213, v214
    v_add_f32 v235, v229, v230
    v_mul_f32 v219, v219, v216
    v_mul_f32 v235, v235, v232
    v_sub_f32 v250, 0, v219
    v_sub_f32 v251, 0, v235
    v_lshlrev_b32 v243, 16, v242
    ds_write_b32 v42, v240
    ds_write_b32 v42, v241 offset:128
    ds_write_b32 v42, v243 offset:256
    ds_write_b32 v42, v244 offset:384
    ds_write_b32 v42, v245 offset:512
    ds_write_b32 v42, v246 offset:640
    ds_write_b32 v42, v247 offset:768
K1_READY:
    s_mov_b32 s93, s57
    s_waitcnt lgkmcnt(0)
    ds_read_b128 v[44:47], v43 offset:128
    ds_read_b128 v[60:63], v43 offset:256
    ds_read_b128 v[48:51], v43 offset:160
    ds_read_b128 v[64:67], v43 offset:288
    ds_read_b128 v[52:55], v43 offset:192
    ds_read_b128 v[68:71], v43 offset:320
    ds_read_b128 v[56:59], v43 offset:224
    ds_read_b128 v[72:75], v43 offset:352
    s_cmp_eq_u32 s51, 2
    s_cbranch_scc1 K1_RV
    ds_read_b128 v[172:175], v43 offset:0
    ds_read_b128 v[176:179], v43 offset:32
    ds_read_b128 v[180:183], v43 offset:64
    ds_read_b128 v[184:187], v43 offset:96
    s_branch K1_RD
K1_RV:
    ds_read_b128 v[172:175], v43 offset:384
    ds_read_b128 v[176:179], v43 offset:416
    ds_read_b128 v[180:183], v43 offset:448
    ds_read_b128 v[184:187], v43 offset:480
    ds_read_b128 v[188:191], v43 offset:512
    ds_read_b128 v[192:195], v43 offset:544
    ds_read_b128 v[196:199], v43 offset:576
    ds_read_b128 v[200:203], v43 offset:608
    ds_read_b128 v[204:207], v43 offset:640
    ds_read_b128 v[208:211], v43 offset:672
    ds_read_b128 v[212:215], v43 offset:704
    ds_read_b128 v[216:219], v43 offset:736
    ds_read_b128 v[220:223], v43 offset:768
    ds_read_b128 v[224:227], v43 offset:800
    ds_read_b128 v[228:231], v43 offset:832
    ds_read_b128 v[232:235], v43 offset:864
K1_RD:
    s_lshl_b32 s55, s36, 2
    s_lshl_b32 s56, s39, 1
    s_add_u32 s55, s55, s56
    s_mul_i32 s58, s55, 110592
    s_mul_i32 s55, s55, 1280
    s_lshr_b32 s59, s50, 4
    s_lshl_b32 s59, s59, 10
    s_add_u32 s58, s58, s59
    s_add_u32 s58, s58, 12582912
    s_add_u32 s59, s58, 110592
    s_waitcnt lgkmcnt(0)
    s_cmp_eq_u32 s51, 2
    s_cbranch_scc1 K1_EPIV
    s_cmp_eq_u32 s51, 1
    s_cselect_b32 s56, 4194304, 0
    s_add_u32 s55, s55, s56
    v_pk_mul_f32 v[76:77], v[246:247], v[172:173] op_sel:[0,0] op_sel_hi:[0,1]
    v_pk_mul_f32 v[78:79], v[246:247], v[174:175] op_sel:[0,0] op_sel_hi:[0,1]
    v_pk_mul_f32 v[80:81], v[246:247], v[176:177] op_sel:[0,0] op_sel_hi:[0,1]
    v_pk_mul_f32 v[82:83], v[246:247], v[178:179] op_sel:[0,0] op_sel_hi:[0,1]
    v_pk_mul_f32 v[84:85], v[246:247], v[180:181] op_sel:[0,0] op_sel_hi:[0,1]
    v_pk_mul_f32 v[86:87], v[246:247], v[182:183] op_sel:[0,0] op_sel_hi:[0,1]
    v_pk_mul_f32 v[88:89], v[246:247], v[184:185] op_sel:[0,0] op_sel_hi:[0,1]
    v_pk_mul_f32 v[90:91], v[246:247], v[186:187] op_sel:[0,0] op_sel_hi:[0,1]
    v_pk_fma_f32 v[76:77], v[244:245], v[108:109], v[76:77] op_sel:[0,0,0] op_sel_hi:[0,1,1]
    v_pk_fma_f32 v[78:79], v[244:245], v[110:111], v[78:79] op_sel:[0,0,0] op_sel_hi:[0,1,1]
    v_pk_fma_f32 v[80:81], v[244:245], v[112:113], v[80:81] op_sel:[0,0,0] op_sel_hi:[0,1,1]
    v_pk_fma_f32 v[82:83], v[244:245], v[114:115], v[82:83] op_sel:[0,0,0] op_sel_hi:[0,1,1]
    v_pk_fma_f32 v[84:85], v[244:245], v[116:117], v[84:85] op_sel:[0,0,0] op_sel_hi:[0,1,1]
    v_pk_fma_f32 v[86:87], v[244:245], v[118:119], v[86:87] op_sel:[0,0,0] op_sel_hi:[0,1,1]
    v_pk_fma_f32 v[88:89], v[244:245], v[120:121], v[88:89] op_sel:[0,0,0] op_sel_hi:[0,1,1]
    v_pk_fma_f32 v[90:91], v[244:245], v[122:123], v[90:91] op_sel:[0,0,0] op_sel_hi:[0,1,1]
    v_cvt_pk_bf16_f32 v92, v76, v77
    v_cvt_pk_bf16_f32 v93, v78, v79
    v_cvt_pk_bf16_f32 v94, v80, v81
    v_cvt_pk_bf16_f32 v95, v82, v83
    v_cvt_pk_bf16_f32 v96, v84, v85
    v_cvt_pk_bf16_f32 v97, v86, v87
    v_cvt_pk_bf16_f32 v98, v88, v89
    v_cvt_pk_bf16_f32 v99, v90, v91
    buffer_store_dwordx2 v[92:93], v252, s[16:19], s55 offen offset:0 sc0 sc1
    buffer_store_dwordx2 v[94:95], v253, s[16:19], s55 offen offset:0 sc0 sc1
    buffer_store_dwordx2 v[96:97], v254, s[16:19], s55 offen offset:0 sc0 sc1
    buffer_store_dwordx2 v[98:99], v255, s[16:19], s55 offen offset:0 sc0 sc1
    v_pk_mul_f32 v[76:77], v[246:247], v[172:173] op_sel:[1,0] op_sel_hi:[1,1]
    v_pk_mul_f32 v[78:79], v[246:247], v[174:175] op_sel:[1,0] op_sel_hi:[1,1]
    v_pk_mul_f32 v[80:81], v[246:247], v[176:177] op_sel:[1,0] op_sel_hi:[1,1]
    v_pk_mul_f32 v[82:83], v[246:247], v[178:179] op_sel:[1,0] op_sel_hi:[1,1]
    v_pk_mul_f32 v[84:85], v[246:247], v[180:181] op_sel:[1,0] op_sel_hi:[1,1]
    v_pk_mul_f32 v[86:87], v[246:247], v[182:183] op_sel:[1,0] op_sel_hi:[1,1]
    v_pk_mul_f32 v[88:89], v[246:247], v[184:185] op_sel:[1,0] op_sel_hi:[1,1]
    v_pk_mul_f32 v[90:91], v[246:247], v[186:187] op_sel:[1,0] op_sel_hi:[1,1]
    v_pk_fma_f32 v[76:77], v[244:245], v[124:125], v[76:77] op_sel:[1,0,0] op_sel_hi:[1,1,1]
    v_pk_fma_f32 v[78:79], v[244:245], v[126:127], v[78:79] op_sel:[1,0,0] op_sel_hi:[1,1,1]
    v_pk_fma_f32 v[80:81], v[244:245], v[128:129], v[80:81] op_sel:[1,0,0] op_sel_hi:[1,1,1]
    v_pk_fma_f32 v[82:83], v[244:245], v[130:131], v[82:83] op_sel:[1,0,0] op_sel_hi:[1,1,1]
    v_pk_fma_f32 v[84:85], v[244:245], v[132:133], v[84:85] op_sel:[1,0,0] op_sel_hi:[1,1,1]
    v_pk_fma_f32 v[86:87], v[244:245], v[134:135], v[86:87] op_sel:[1,0,0] op_sel_hi:[1,1,1]
    v_pk_fma_f32 v[88:89], v[244:245], v[136:137], v[88:89] op_sel:[1,0,0] op_sel_hi:[1,1,1]
    v_pk_fma_f32 v[90:91], v[244:245], v[138:139], v[90:91] op_sel:[1,0,0] op_sel_hi:[1,1,1]
    v_cvt_pk_bf16_f32 v100, v76, v77
    v_cvt_pk_bf16_f32 v101, v78, v79
    v_cvt_pk_bf16_f32 v102, v80, v81
    v_cvt_pk_bf16_f32 v103, v82, v83
    v_cvt_pk_bf16_f32 v104, v84, v85
    v_cvt_pk_bf16_f32 v105, v86, v87
    v_cvt_pk_bf16_f32 v106, v88, v89
    v_cvt_pk_bf16_f32 v107, v90, v91
    buffer_store_dwordx2 v[100:101], v252, s[16:19], s55 offen offset:1280 sc0 sc1
    buffer_store_dwordx2 v[102:103], v253, s[16:19], s55 offen offset:1280 sc0 sc1
    buffer_store_dwordx2 v[104:105], v254, s[16:19], s55 offen offset:1280 sc0 sc1
    buffer_store_dwordx2 v[106:107], v255, s[16:19], s55 offen offset:1280 sc0 sc1
    s_branch K1_EPIH
K1_EPIV:
    s_add_u32 s55, s55, 8388608
    v_pk_mul_f32 v[76:77], v[240:241], v[204:205] op_sel:[0,0] op_sel_hi:[0,1]
    v_pk_mul_f32 v[78:79], v[240:241], v[206:207] op_sel:[0,0] op_sel_hi:[0,1]
    v_pk_mul_f32 v[80:81], v[240:241], v[208:209] op_sel:[0,0] op_sel_hi:[0,1]
    v_pk_mul_f32 v[82:83], v[240:241], v[210:211] op_sel:[0,0] op_sel_hi:[0,1]
    v_pk_mul_f32 v[84:85], v[240:241], v[212:213] op_sel:[0,0] op_sel_hi:[0,1]
    v_pk_mul_f32 v[86:87], v[240:241], v[214:215] op_sel:[0,0] op_sel_hi:[0,1]
    v_pk_mul_f32 v[88:89], v[240:241], v[216:217] op_sel:[0,0] op_sel_hi:[0,1]
    v_pk_mul_f32 v[90:91], v[240:241], v[218:219] op_sel:[0,0] op_sel_hi:[0,1]
    v_pk_fma_f32 v[76:77], v[172:173], v[108:109], v[76:77]
    v_pk_fma_f32 v[78:79], v[174:175], v[110:111], v[78:79]
    v_pk_fma_f32 v[80:81], v[176:177], v[112:113], v[80:81]
    v_pk_fma_f32 v[82:83], v[178:179], v[114:115], v[82:83]
    v_pk_fma_f32 v[84:85], v[180:181], v[116:117], v[84:85]
    v_pk_fma_f32 v[86:87], v[182:183], v[118:119], v[86:87]
    v_pk_fma_f32 v[88:89], v[184:185], v[120:121], v[88:89]
    v_pk_fma_f32 v[90:91], v[186:187], v[122:123], v[90:91]
    v_cvt_pk_bf16_f32 v92, v76, v77
    v_cvt_pk_bf16_f32 v93, v78, v79
    v_cvt_pk_bf16_f32 v94, v80, v81
    v_cvt_pk_bf16_f32 v95, v82, v83
    v_cvt_pk_bf16_f32 v96, v84, v85
    v_cvt_pk_bf16_f32 v97, v86, v87
    v_cvt_pk_bf16_f32 v98, v88, v89
    v_cvt_pk_bf16_f32 v99, v90, v91
    buffer_store_dwordx4 v[92:95], v252, s[16:19], s55 offen offset:0 sc0 sc1
    buffer_store_dwordx4 v[96:99], v252, s[16:19], s55 offen offset:640 sc0 sc1
    v_pk_mul_f32 v[76:77], v[240:241], v[220:221] op_sel:[0,0] op_sel_hi:[0,1]
    v_pk_mul_f32 v[78:79], v[240:241], v[222:223] op_sel:[0,0] op_sel_hi:[0,1]
    v_pk_mul_f32 v[80:81], v[240:241], v[224:225] op_sel:[0,0] op_sel_hi:[0,1]
    v_pk_mul_f32 v[82:83], v[240:241], v[226:227] op_sel:[0,0] op_sel_hi:[0,1]
    v_pk_mul_f32 v[84:85], v[240:241], v[228:229] op_sel:[0,0] op_sel_hi:[0,1]
    v_pk_mul_f32 v[86:87], v[240:241], v[230:231] op_sel:[0,0] op_sel_hi:[0,1]
    v_pk_mul_f32 v[88:89], v[240:241], v[232:233] op_sel:[0,0] op_sel_hi:[0,1]
    v_pk_mul_f32 v[90:91], v[240:241], v[234:235] op_sel:[0,0] op_sel_hi:[0,1]
    v_pk_fma_f32 v[76:77], v[188:189], v[124:125], v[76:77]
    v_pk_fma_f32 v[78:79], v[190:191], v[126:127], v[78:79]
    v_pk_fma_f32 v[80:81], v[192:193], v[128:129], v[80:81]
    v_pk_fma_f32 v[82:83], v[194:195], v[130:131], v[82:83]
    v_pk_fma_f32 v[84:85], v[196:197], v[132:133], v[84:85]
    v_pk_fma_f32 v[86:87], v[198:199], v[134:135], v[86:87]
    v_pk_fma_f32 v[88:89], v[200:201], v[136:137], v[88:89]
    v_pk_fma_f32 v[90:91], v[202:203], v[138:139], v[90:91]
    v_cvt_pk_bf16_f32 v100, v76, v77
    v_cvt_pk_bf16_f32 v101, v78, v79
    v_cvt_pk_bf16_f32 v102, v80, v81
    v_cvt_pk_bf16_f32 v103, v82, v83
    v_cvt_pk_bf16_f32 v104, v84, v85
    v_cvt_pk_bf16_f32 v105, v86, v87
    v_cvt_pk_bf16_f32 v106, v88, v89
    v_cvt_pk_bf16_f32 v107, v90, v91
    buffer_store_dwordx4 v[100:103], v252, s[16:19], s55 offen offset:1280 sc0 sc1
    buffer_store_dwordx4 v[104:107], v252, s[16:19], s55 offen offset:1920 sc0 sc1
K1_EPIH:
    s_cmp_eq_u32 s54, 0
    s_cbranch_scc1 K1_FIN
    v_mov_b32 v10, 3184710632
    v_mov_b32 v11, 3184710632
    v_mov_b32 v12, 3222493025
    v_mov_b32 v13, 3222493025
    v_mov_b32 v14, 1.0
    v_mov_b32 v15, 1.0
    v_lshlrev_b32 v9, 4, v1
    v_pk_fma_f32 v[172:173], v[250:251], v[44:45], v[60:61] op_sel:[0,0,0] op_sel_hi:[0,1,1]
    v_pk_fma_f32 v[174:175], v[250:251], v[46:47], v[62:63] op_sel:[0,0,0] op_sel_hi:[0,1,1]
    v_pk_fma_f32 v[176:177], v[250:251], v[48:49], v[64:65] op_sel:[0,0,0] op_sel_hi:[0,1,1]
    v_pk_fma_f32 v[178:179], v[250:251], v[50:51], v[66:67] op_sel:[0,0,0] op_sel_hi:[0,1,1]
    v_pk_fma_f32 v[180:181], v[250:251], v[52:53], v[68:69] op_sel:[0,0,0] op_sel_hi:[0,1,1]
    v_pk_fma_f32 v[182:183], v[250:251], v[54:55], v[70:71] op_sel:[0,0,0] op_sel_hi:[0,1,1]
    v_pk_fma_f32 v[184:185], v[250:251], v[56:57], v[72:73] op_sel:[0,0,0] op_sel_hi:[0,1,1]
    v_pk_fma_f32 v[186:187], v[250:251], v[58:59], v[74:75] op_sel:[0,0,0] op_sel_hi:[0,1,1]
    v_pk_fma_f32 v[140:141], v[248:249], v[140:141], v[172:173] op_sel:[0,0,0] op_sel_hi:[0,1,1]
    v_pk_fma_f32 v[142:143], v[248:249], v[142:143], v[174:175] op_sel:[0,0,0] op_sel_hi:[0,1,1]
    v_pk_fma_f32 v[144:145], v[248:249], v[144:145], v[176:177] op_sel:[0,0,0] op_sel_hi:[0,1,1]
    v_pk_fma_f32 v[146:147], v[248:249], v[146:147], v[178:179] op_sel:[0,0,0] op_sel_hi:[0,1,1]
    v_pk_fma_f32 v[148:149], v[248:249], v[148:149], v[180:181] op_sel:[0,0,0] op_sel_hi:[0,1,1]
    v_pk_fma_f32 v[150:151], v[248:249], v[150:151], v[182:183] op_sel:[0,0,0] op_sel_hi:[0,1,1]
    v_pk_fma_f32 v[152:153], v[248:249], v[152:153], v[184:185] op_sel:[0,0,0] op_sel_hi:[0,1,1]
    v_pk_fma_f32 v[154:155], v[248:249], v[154:155], v[186:187] op_sel:[0,0,0] op_sel_hi:[0,1,1]
    v_pk_mul_f32 v[172:173], v[140:141], v[140:141]
    v_pk_mul_f32 v[174:175], v[142:143], v[142:143]
    v_pk_mul_f32 v[176:177], v[144:145], v[144:145]
    v_pk_mul_f32 v[178:179], v[146:147], v[146:147]
    v_pk_mul_f32 v[180:181], v[148:149], v[148:149]
    v_pk_mul_f32 v[182:183], v[150:151], v[150:151]
    v_pk_mul_f32 v[184:185], v[152:153], v[152:153]
    v_pk_mul_f32 v[186:187], v[154:155], v[154:155]
    v_pk_fma_f32 v[172:173], v[172:173], v[10:11], v[12:13]
    v_pk_fma_f32 v[174:175], v[174:175], v[10:11], v[12:13]
    v_pk_fma_f32 v[176:177], v[176:177], v[10:11], v[12:13]
    v_pk_fma_f32 v[178:179], v[178:179], v[10:11], v[12:13]
    v_pk_fma_f32 v[180:181], v[180:181], v[10:11], v[12:13]
    v_pk_fma_f32 v[182:183], v[182:183], v[10:11], v[12:13]
    v_pk_fma_f32 v[184:185], v[184:185], v[10:11], v[12:13]
    v_pk_fma_f32 v[186:187], v[186:187], v[10:11], v[12:13]
    v_pk_mul_f32 v[172:173], v[172:173], v[140:141]
    v_pk_mul_f32 v[174:175], v[174:175], v[142:143]
    v_pk_mul_f32 v[176:177], v[176:177], v[144:145]
    v_pk_mul_f32 v[178:179], v[178:179], v[146:147]
    v_pk_mul_f32 v[180:181], v[180:181], v[148:149]
    v_pk_mul_f32 v[182:183], v[182:183], v[150:151]
    v_pk_mul_f32 v[184:185], v[184:185], v[152:153]
    v_pk_mul_f32 v[186:187], v[186:187], v[154:155]
    v_exp_f32 v172, v172
    v_exp_f32 v173, v173
    v_exp_f32 v174, v174
    v_exp_f32 v175, v175
    v_exp_f32 v176, v176
    v_exp_f32 v177, v177
    v_exp_f32 v178, v178
    v_exp_f32 v179, v179
    v_exp_f32 v180, v180
    v_exp_f32 v181, v181
    v_exp_f32 v182, v182
    v_exp_f32 v183, v183
    v_exp_f32 v184, v184
    v_exp_f32 v185, v185
    v_exp_f32 v186, v186
    v_exp_f32 v187, v187
    v_pk_add_f32 v[172:173], v[172:173], v[14:15]
    v_pk_add_f32 v[174:175], v[174:175], v[14:15]
    v_pk_add_f32 v[176:177], v[176:177], v[14:15]
    v_pk_add_f32 v[178:179], v[178:179], v[14:15]
    v_pk_add_f32 v[180:181], v[180:181], v[14:15]
    v_pk_add_f32 v[182:183], v[182:183], v[14:15]
    v_pk_add_f32 v[184:185], v[184:185], v[14:15]
    v_pk_add_f32 v[186:187], v[186:187], v[14:15]
    v_rcp_f32 v172, v172
    v_rcp_f32 v173, v173
    v_rcp_f32 v174, v174
    v_rcp_f32 v175, v175
    v_rcp_f32 v176, v176
    v_rcp_f32 v177, v177
    v_rcp_f32 v178, v178
    v_rcp_f32 v179, v179
    v_rcp_f32 v180, v180
    v_rcp_f32 v181, v181
    v_rcp_f32 v182, v182
    v_rcp_f32 v183, v183
    v_rcp_f32 v184, v184
    v_rcp_f32 v185, v185
    v_rcp_f32 v186, v186
    v_rcp_f32 v187, v187
    v_pk_mul_f32 v[172:173], v[172:173], v[140:141]
    v_pk_mul_f32 v[174:175], v[174:175], v[142:143]
    v_pk_mul_f32 v[176:177], v[176:177], v[144:145]
    v_pk_mul_f32 v[178:179], v[178:179], v[146:147]
    v_pk_mul_f32 v[180:181], v[180:181], v[148:149]
    v_pk_mul_f32 v[182:183], v[182:183], v[150:151]
    v_pk_mul_f32 v[184:185], v[184:185], v[152:153]
    v_pk_mul_f32 v[186:187], v[186:187], v[154:155]
    v_cvt_pk_bf16_f32 v204, v172, v173
    v_cvt_pk_bf16_f32 v205, v174, v175
    v_cvt_pk_bf16_f32 v206, v176, v177
    v_cvt_pk_bf16_f32 v207, v178, v179
    v_cvt_pk_bf16_f32 v208, v180, v181
    v_cvt_pk_bf16_f32 v209, v182, v183
    v_cvt_pk_bf16_f32 v210, v184, v185
    v_cvt_pk_bf16_f32 v211, v186, v187
    buffer_store_dwordx4 v[204:207], v9, s[16:19], s58 offen sc0 sc1
    buffer_store_dwordx4 v[208:211], v9, s[16:19], s58 offen offset:1024 sc0 sc1
    v_pk_fma_f32 v[188:189], v[250:251], v[44:45], v[60:61] op_sel:[1,0,0] op_sel_hi:[1,1,1]
    v_pk_fma_f32 v[190:191], v[250:251], v[46:47], v[62:63] op_sel:[1,0,0] op_sel_hi:[1,1,1]
    v_pk_fma_f32 v[192:193], v[250:251], v[48:49], v[64:65] op_sel:[1,0,0] op_sel_hi:[1,1,1]
    v_pk_fma_f32 v[194:195], v[250:251], v[50:51], v[66:67] op_sel:[1,0,0] op_sel_hi:[1,1,1]
    v_pk_fma_f32 v[196:197], v[250:251], v[52:53], v[68:69] op_sel:[1,0,0] op_sel_hi:[1,1,1]
    v_pk_fma_f32 v[198:199], v[250:251], v[54:55], v[70:71] op_sel:[1,0,0] op_sel_hi:[1,1,1]
    v_pk_fma_f32 v[200:201], v[250:251], v[56:57], v[72:73] op_sel:[1,0,0] op_sel_hi:[1,1,1]
    v_pk_fma_f32 v[202:203], v[250:251], v[58:59], v[74:75] op_sel:[1,0,0] op_sel_hi:[1,1,1]
    v_pk_fma_f32 v[156:157], v[248:249], v[156:157], v[188:189] op_sel:[1,0,0] op_sel_hi:[1,1,1]
    v_pk_fma_f32 v[158:159], v[248:249], v[158:159], v[190:191] op_sel:[1,0,0] op_sel_hi:[1,1,1]
    v_pk_fma_f32 v[160:161], v[248:249], v[160:161], v[192:193] op_sel:[1,0,0] op_sel_hi:[1,1,1]
    v_pk_fma_f32 v[162:163], v[248:249], v[162:163], v[194:195] op_sel:[1,0,0] op_sel_hi:[1,1,1]
    v_pk_fma_f32 v[164:165], v[248:249], v[164:165], v[196:197] op_sel:[1,0,0] op_sel_hi:[1,1,1]
    v_pk_fma_f32 v[166:167], v[248:249], v[166:167], v[198:199] op_sel:[1,0,0] op_sel_hi:[1,1,1]
    v_pk_fma_f32 v[168:169], v[248:249], v[168:169], v[200:201] op_sel:[1,0,0] op_sel_hi:[1,1,1]
    v_pk_fma_f32 v[170:171], v[248:249], v[170:171], v[202:203] op_sel:[1,0,0] op_sel_hi:[1,1,1]
    v_pk_mul_f32 v[188:189], v[156:157], v[156:157]
    v_pk_mul_f32 v[190:191], v[158:159], v[158:159]
    v_pk_mul_f32 v[192:193], v[160:161], v[160:161]
    v_pk_mul_f32 v[194:195], v[162:163], v[162:163]
    v_pk_mul_f32 v[196:197], v[164:165], v[164:165]
    v_pk_mul_f32 v[198:199], v[166:167], v[166:167]
    v_pk_mul_f32 v[200:201], v[168:169], v[168:169]
    v_pk_mul_f32 v[202:203], v[170:171], v[170:171]
    v_pk_fma_f32 v[188:189], v[188:189], v[10:11], v[12:13]
    v_pk_fma_f32 v[190:191], v[190:191], v[10:11], v[12:13]
    v_pk_fma_f32 v[192:193], v[192:193], v[10:11], v[12:13]
    v_pk_fma_f32 v[194:195], v[194:195], v[10:11], v[12:13]
    v_pk_fma_f32 v[196:197], v[196:197], v[10:11], v[12:13]
    v_pk_fma_f32 v[198:199], v[198:199], v[10:11], v[12:13]
    v_pk_fma_f32 v[200:201], v[200:201], v[10:11], v[12:13]
    v_pk_fma_f32 v[202:203], v[202:203], v[10:11], v[12:13]
    v_pk_mul_f32 v[188:189], v[188:189], v[156:157]
    v_pk_mul_f32 v[190:191], v[190:191], v[158:159]
    v_pk_mul_f32 v[192:193], v[192:193], v[160:161]
    v_pk_mul_f32 v[194:195], v[194:195], v[162:163]
    v_pk_mul_f32 v[196:197], v[196:197], v[164:165]
    v_pk_mul_f32 v[198:199], v[198:199], v[166:167]
    v_pk_mul_f32 v[200:201], v[200:201], v[168:169]
    v_pk_mul_f32 v[202:203], v[202:203], v[170:171]
    v_exp_f32 v188, v188
    v_exp_f32 v189, v189
    v_exp_f32 v190, v190
    v_exp_f32 v191, v191
    v_exp_f32 v192, v192
    v_exp_f32 v193, v193
    v_exp_f32 v194, v194
    v_exp_f32 v195, v195
    v_exp_f32 v196, v196
    v_exp_f32 v197, v197
    v_exp_f32 v198, v198
    v_exp_f32 v199, v199
    v_exp_f32 v200, v200
    v_exp_f32 v201, v201
    v_exp_f32 v202, v202
    v_exp_f32 v203, v203
    v_pk_add_f32 v[188:189], v[188:189], v[14:15]
    v_pk_add_f32 v[190:191], v[190:191], v[14:15]
    v_pk_add_f32 v[192:193], v[192:193], v[14:15]
    v_pk_add_f32 v[194:195], v[194:195], v[14:15]
    v_pk_add_f32 v[196:197], v[196:197], v[14:15]
    v_pk_add_f32 v[198:199], v[198:199], v[14:15]
    v_pk_add_f32 v[200:201], v[200:201], v[14:15]
    v_pk_add_f32 v[202:203], v[202:203], v[14:15]
    v_rcp_f32 v188, v188
    v_rcp_f32 v189, v189
    v_rcp_f32 v190, v190
    v_rcp_f32 v191, v191
    v_rcp_f32 v192, v192
    v_rcp_f32 v193, v193
    v_rcp_f32 v194, v194
    v_rcp_f32 v195, v195
    v_rcp_f32 v196, v196
    v_rcp_f32 v197, v197
    v_rcp_f32 v198, v198
    v_rcp_f32 v199, v199
    v_rcp_f32 v200, v200
    v_rcp_f32 v201, v201
    v_rcp_f32 v202, v202
    v_rcp_f32 v203, v203
    v_pk_mul_f32 v[188:189], v[188:189], v[156:157]
    v_pk_mul_f32 v[190:191], v[190:191], v[158:159]
    v_pk_mul_f32 v[192:193], v[192:193], v[160:161]
    v_pk_mul_f32 v[194:195], v[194:195], v[162:163]
    v_pk_mul_f32 v[196:197], v[196:197], v[164:165]
    v_pk_mul_f32 v[198:199], v[198:199], v[166:167]
    v_pk_mul_f32 v[200:201], v[200:201], v[168:169]
    v_pk_mul_f32 v[202:203], v[202:203], v[170:171]
    v_cvt_pk_bf16_f32 v212, v188, v189
    v_cvt_pk_bf16_f32 v213, v190, v191
    v_cvt_pk_bf16_f32 v214, v192, v193
    v_cvt_pk_bf16_f32 v215, v194, v195
    v_cvt_pk_bf16_f32 v216, v196, v197
    v_cvt_pk_bf16_f32 v217, v198, v199
    v_cvt_pk_bf16_f32 v218, v200, v201
    v_cvt_pk_bf16_f32 v219, v202, v203
    buffer_store_dwordx4 v[212:215], v9, s[16:19], s59 offen sc0 sc1
    buffer_store_dwordx4 v[216:219], v9, s[16:19], s59 offen offset:1024 sc0 sc1
    s_branch K1_FIN
K1_TRANS:
    s_mov_b32 s8, s32
    s_mov_b32 s9, s33
    s_mov_b32 s10, 2211840
    s_mov_b32 s11, 0x00020000
    s_mov_b32 s12, s34
    s_mov_b32 s13, s35
    s_mov_b32 s14, 819200
    s_mov_b32 s15, 0x00020000
    s_lshl_b32 s63, s36, 3
    s_add_u32 s63, s63, s38
    s_mul_i32 s39, s38, 12288
    v_lshrrev_b32 v2, 2, v1
    v_and_b32 v3, 3, v1
    v_lshrrev_b32 v4, 3, v2
    v_and_b32 v5, 7, v2
    v_lshrrev_b32 v6, 2, v5
    v_lshl_add_u32 v7, v4, 2, v5
    v_lshl_add_u32 v7, v6, 2, v7
    v_mul_u32_u24 v7, 1280, v7
    v_lshl_add_u32 v7, v3, 4, v7
    v_mul_u32_u24 v8, 40, v4
    v_add_u32 v8, v8, v5
    v_lshl_add_u32 v8, v6, 4, v8
    v_mul_u32_u24 v8, 1280, v8
    v_lshl_add_u32 v8, v3, 4, v8
    v_and_b32 v2, 15, v1
    v_lshrrev_b32 v3, 2, v2
    v_and_b32 v4, 3, v2
    v_lshrrev_b32 v5, 4, v1
    v_and_b32 v6, 1, v5
    v_lshrrev_b32 v5, 1, v5
    v_lshl_add_u32 v5, v5, 3, v3
    v_lshlrev_b32 v5, 6, v5
    v_lshl_add_u32 v5, v6, 5, v5
    v_lshl_add_u32 v5, v4, 3, v5
    v_add_u32 v9, s39, v5
    v_lshlrev_b32 v10, 4, v1
    s_mov_b32 s62, 0
K1_TB:
    s_mov_b32 s40, 0
    s_cmp_ge_u32 s63, 2960
    s_cbranch_scc1 K1_TI0
    s_add_u32 m0, s39, 0
    s_cmp_lt_u32 s63, 2160
    s_cbranch_scc0 K1_TW0
    s_mul_hi_u32 s57, s63, 39768216
    s_mul_i32 s58, s57, 108
    s_sub_u32 s58, s63, s58
    s_lshl_b32 s59, s63, 10
    s_add_u32 s40, s59, 20971520
    s_mul_i32 s58, s58, 20480
    s_lshl_b32 s57, s57, 6
    s_add_u32 s58, s58, s57
    buffer_load_dwordx4 v7, s[8:11], s58 offen lds
    s_branch K1_TN0
K1_TW0:
    s_sub_u32 s56, s63, 2160
    s_mul_hi_u32 s57, s56, 107374183
    s_mul_i32 s58, s57, 40
    s_sub_u32 s58, s56, s58
    s_lshl_b32 s59, s56, 10
    s_add_u32 s40, s59, 25165824
    s_lshl_b32 s57, s57, 6
    s_cmp_ge_u32 s58, 32
    s_cbranch_scc1 K1_TR0
    s_mul_i32 s58, s58, 25600
    s_add_u32 s58, s58, s57
    buffer_load_dwordx4 v7, s[12:15], s58 offen lds
    s_branch K1_TN0
K1_TR0:
    s_sub_u32 s58, s58, 32
    s_mul_i32 s58, s58, 102400
    s_add_u32 s58, s58, 20480
    s_add_u32 s58, s58, s57
    buffer_load_dwordx4 v8, s[12:15], s58 offen lds
K1_TN0:
    s_add_u32 s63, s63, 128
K1_TI0:
    s_mov_b32 s41, 0
    s_cmp_ge_u32 s63, 2960
    s_cbranch_scc1 K1_TI1
    s_add_u32 m0, s39, 1024
    s_cmp_lt_u32 s63, 2160
    s_cbranch_scc0 K1_TW1
    s_mul_hi_u32 s57, s63, 39768216
    s_mul_i32 s58, s57, 108
    s_sub_u32 s58, s63, s58
    s_lshl_b32 s59, s63, 10
    s_add_u32 s41, s59, 20971520
    s_mul_i32 s58, s58, 20480
    s_lshl_b32 s57, s57, 6
    s_add_u32 s58, s58, s57
    buffer_load_dwordx4 v7, s[8:11], s58 offen lds
    s_branch K1_TN1
K1_TW1:
    s_sub_u32 s56, s63, 2160
    s_mul_hi_u32 s57, s56, 107374183
    s_mul_i32 s58, s57, 40
    s_sub_u32 s58, s56, s58
    s_lshl_b32 s59, s56, 10
    s_add_u32 s41, s59, 25165824
    s_lshl_b32 s57, s57, 6
    s_cmp_ge_u32 s58, 32
    s_cbranch_scc1 K1_TR1
    s_mul_i32 s58, s58, 25600
    s_add_u32 s58, s58, s57
    buffer_load_dwordx4 v7, s[12:15], s58 offen lds
    s_branch K1_TN1
K1_TR1:
    s_sub_u32 s58, s58, 32
    s_mul_i32 s58, s58, 102400
    s_add_u32 s58, s58, 20480
    s_add_u32 s58, s58, s57
    buffer_load_dwordx4 v8, s[12:15], s58 offen lds
K1_TN1:
    s_add_u32 s63, s63, 128
K1_TI1:
    s_mov_b32 s42, 0
    s_cmp_ge_u32 s63, 2960
    s_cbranch_scc1 K1_TI2
    s_add_u32 m0, s39, 2048
    s_cmp_lt_u32 s63, 2160
    s_cbranch_scc0 K1_TW2
    s_mul_hi_u32 s57, s63, 39768216
    s_mul_i32 s58, s57, 108
    s_sub_u32 s58, s63, s58
    s_lshl_b32 s59, s63, 10
    s_add_u32 s42, s59, 20971520
    s_mul_i32 s58, s58, 20480
    s_lshl_b32 s57, s57, 6
    s_add_u32 s58, s58, s57
    buffer_load_dwordx4 v7, s[8:11], s58 offen lds
    s_branch K1_TN2
K1_TW2:
    s_sub_u32 s56, s63, 2160
    s_mul_hi_u32 s57, s56, 107374183
    s_mul_i32 s58, s57, 40
    s_sub_u32 s58, s56, s58
    s_lshl_b32 s59, s56, 10
    s_add_u32 s42, s59, 25165824
    s_lshl_b32 s57, s57, 6
    s_cmp_ge_u32 s58, 32
    s_cbranch_scc1 K1_TR2
    s_mul_i32 s58, s58, 25600
    s_add_u32 s58, s58, s57
    buffer_load_dwordx4 v7, s[12:15], s58 offen lds
    s_branch K1_TN2
K1_TR2:
    s_sub_u32 s58, s58, 32
    s_mul_i32 s58, s58, 102400
    s_add_u32 s58, s58, 20480
    s_add_u32 s58, s58, s57
    buffer_load_dwordx4 v8, s[12:15], s58 offen lds
K1_TN2:
    s_add_u32 s63, s63, 128
K1_TI2:
    s_mov_b32 s43, 0
    s_cmp_ge_u32 s63, 2960
    s_cbranch_scc1 K1_TI3
    s_add_u32 m0, s39, 3072
    s_cmp_lt_u32 s63, 2160
    s_cbranch_scc0 K1_TW3
    s_mul_hi_u32 s57, s63, 39768216
    s_mul_i32 s58, s57, 108
    s_sub_u32 s58, s63, s58
    s_lshl_b32 s59, s63, 10
    s_add_u32 s43, s59, 20971520
    s_mul_i32 s58, s58, 20480
    s_lshl_b32 s57, s57, 6
    s_add_u32 s58, s58, s57
    buffer_load_dwordx4 v7, s[8:11], s58 offen lds
    s_branch K1_TN3
K1_TW3:
    s_sub_u32 s56, s63, 2160
    s_mul_hi_u32 s57, s56, 107374183
    s_mul_i32 s58, s57, 40
    s_sub_u32 s58, s56, s58
    s_lshl_b32 s59, s56, 10
    s_add_u32 s43, s59, 25165824
    s_lshl_b32 s57, s57, 6
    s_cmp_ge_u32 s58, 32
    s_cbranch_scc1 K1_TR3
    s_mul_i32 s58, s58, 25600
    s_add_u32 s58, s58, s57
    buffer_load_dwordx4 v7, s[12:15], s58 offen lds
    s_branch K1_TN3
K1_TR3:
    s_sub_u32 s58, s58, 32
    s_mul_i32 s58, s58, 102400
    s_add_u32 s58, s58, 20480
    s_add_u32 s58, s58, s57
    buffer_load_dwordx4 v8, s[12:15], s58 offen lds
K1_TN3:
    s_add_u32 s63, s63, 128
K1_TI3:
    s_mov_b32 s44, 0
    s_cmp_ge_u32 s63, 2960
    s_cbranch_scc1 K1_TI4
    s_add_u32 m0, s39, 4096
    s_cmp_lt_u32 s63, 2160
    s_cbranch_scc0 K1_TW4
    s_mul_hi_u32 s57, s63, 39768216
    s_mul_i32 s58, s57, 108
    s_sub_u32 s58, s63, s58
    s_lshl_b32 s59, s63, 10
    s_add_u32 s44, s59, 20971520
    s_mul_i32 s58, s58, 20480
    s_lshl_b32 s57, s57, 6
    s_add_u32 s58, s58, s57
    buffer_load_dwordx4 v7, s[8:11], s58 offen lds
    s_branch K1_TN4
K1_TW4:
    s_sub_u32 s56, s63, 2160
    s_mul_hi_u32 s57, s56, 107374183
    s_mul_i32 s58, s57, 40
    s_sub_u32 s58, s56, s58
    s_lshl_b32 s59, s56, 10
    s_add_u32 s44, s59, 25165824
    s_lshl_b32 s57, s57, 6
    s_cmp_ge_u32 s58, 32
    s_cbranch_scc1 K1_TR4
    s_mul_i32 s58, s58, 25600
    s_add_u32 s58, s58, s57
    buffer_load_dwordx4 v7, s[12:15], s58 offen lds
    s_branch K1_TN4
K1_TR4:
    s_sub_u32 s58, s58, 32
    s_mul_i32 s58, s58, 102400
    s_add_u32 s58, s58, 20480
    s_add_u32 s58, s58, s57
    buffer_load_dwordx4 v8, s[12:15], s58 offen lds
K1_TN4:
    s_add_u32 s63, s63, 128
K1_TI4:
    s_mov_b32 s45, 0
    s_cmp_ge_u32 s63, 2960
    s_cbranch_scc1 K1_TI5
    s_add_u32 m0, s39, 5120
    s_cmp_lt_u32 s63, 2160
    s_cbranch_scc0 K1_TW5
    s_mul_hi_u32 s57, s63, 39768216
    s_mul_i32 s58, s57, 108
    s_sub_u32 s58, s63, s58
    s_lshl_b32 s59, s63, 10
    s_add_u32 s45, s59, 20971520
    s_mul_i32 s58, s58, 20480
    s_lshl_b32 s57, s57, 6
    s_add_u32 s58, s58, s57
    buffer_load_dwordx4 v7, s[8:11], s58 offen lds
    s_branch K1_TN5
K1_TW5:
    s_sub_u32 s56, s63, 2160
    s_mul_hi_u32 s57, s56, 107374183
    s_mul_i32 s58, s57, 40
    s_sub_u32 s58, s56, s58
    s_lshl_b32 s59, s56, 10
    s_add_u32 s45, s59, 25165824
    s_lshl_b32 s57, s57, 6
    s_cmp_ge_u32 s58, 32
    s_cbranch_scc1 K1_TR5
    s_mul_i32 s58, s58, 25600
    s_add_u32 s58, s58, s57
    buffer_load_dwordx4 v7, s[12:15], s58 offen lds
    s_branch K1_TN5
K1_TR5:
    s_sub_u32 s58, s58, 32
    s_mul_i32 s58, s58, 102400
    s_add_u32 s58, s58, 20480
    s_add_u32 s58, s58, s57
    buffer_load_dwordx4 v8, s[12:15], s58 offen lds
K1_TN5:
    s_add_u32 s63, s63, 128
K1_TI5:
    s_mov_b32 s46, 0
    s_cmp_ge_u32 s63, 2960
    s_cbranch_scc1 K1_TI6
    s_add_u32 m0, s39, 6144
    s_cmp_lt_u32 s63, 2160
    s_cbranch_scc0 K1_TW6
    s_mul_hi_u32 s57, s63, 39768216
    s_mul_i32 s58, s57, 108
    s_sub_u32 s58, s63, s58
    s_lshl_b32 s59, s63, 10
    s_add_u32 s46, s59, 20971520
    s_mul_i32 s58, s58, 20480
    s_lshl_b32 s57, s57, 6
    s_add_u32 s58, s58, s57
    buffer_load_dwordx4 v7, s[8:11], s58 offen lds
    s_branch K1_TN6
K1_TW6:
    s_sub_u32 s56, s63, 2160
    s_mul_hi_u32 s57, s56, 107374183
    s_mul_i32 s58, s57, 40
    s_sub_u32 s58, s56, s58
    s_lshl_b32 s59, s56, 10
    s_add_u32 s46, s59, 25165824
    s_lshl_b32 s57, s57, 6
    s_cmp_ge_u32 s58, 32
    s_cbranch_scc1 K1_TR6
    s_mul_i32 s58, s58, 25600
    s_add_u32 s58, s58, s57
    buffer_load_dwordx4 v7, s[12:15], s58 offen lds
    s_branch K1_TN6
K1_TR6:
    s_sub_u32 s58, s58, 32
    s_mul_i32 s58, s58, 102400
    s_add_u32 s58, s58, 20480
    s_add_u32 s58, s58, s57
    buffer_load_dwordx4 v8, s[12:15], s58 offen lds
K1_TN6:
    s_add_u32 s63, s63, 128
K1_TI6:
    s_mov_b32 s47, 0
    s_cmp_ge_u32 s63, 2960
    s_cbranch_scc1 K1_TI7
    s_add_u32 m0, s39, 7168
    s_cmp_lt_u32 s63, 2160
    s_cbranch_scc0 K1_TW7
    s_mul_hi_u32 s57, s63, 39768216
    s_mul_i32 s58, s57, 108
    s_sub_u32 s58, s63, s58
    s_lshl_b32 s59, s63, 10
    s_add_u32 s47, s59, 20971520
    s_mul_i32 s58, s58, 20480
    s_lshl_b32 s57, s57, 6
    s_add_u32 s58, s58, s57
    buffer_load_dwordx4 v7, s[8:11], s58 offen lds
    s_branch K1_TN7
K1_TW7:
    s_sub_u32 s56, s63, 2160
    s_mul_hi_u32 s57, s56, 107374183
    s_mul_i32 s58, s57, 40
    s_sub_u32 s58, s56, s58
    s_lshl_b32 s59, s56, 10
    s_add_u32 s47, s59, 25165824
    s_lshl_b32 s57, s57, 6
    s_cmp_ge_u32 s58, 32
    s_cbranch_scc1 K1_TR7
    s_mul_i32 s58, s58, 25600
    s_add_u32 s58, s58, s57
    buffer_load_dwordx4 v7, s[12:15], s58 offen lds
    s_branch K1_TN7
K1_TR7:
    s_sub_u32 s58, s58, 32
    s_mul_i32 s58, s58, 102400
    s_add_u32 s58, s58, 20480
    s_add_u32 s58, s58, s57
    buffer_load_dwordx4 v8, s[12:15], s58 offen lds
K1_TN7:
    s_add_u32 s63, s63, 128
K1_TI7:
    s_mov_b32 s48, 0
    s_cmp_ge_u32 s63, 2960
    s_cbranch_scc1 K1_TI8
    s_add_u32 m0, s39, 8192
    s_cmp_lt_u32 s63, 2160
    s_cbranch_scc0 K1_TW8
    s_mul_hi_u32 s57, s63, 39768216
    s_mul_i32 s58, s57, 108
    s_sub_u32 s58, s63, s58
    s_lshl_b32 s59, s63, 10
    s_add_u32 s48, s59, 20971520
    s_mul_i32 s58, s58, 20480
    s_lshl_b32 s57, s57, 6
    s_add_u32 s58, s58, s57
    buffer_load_dwordx4 v7, s[8:11], s58 offen lds
    s_branch K1_TN8
K1_TW8:
    s_sub_u32 s56, s63, 2160
    s_mul_hi_u32 s57, s56, 107374183
    s_mul_i32 s58, s57, 40
    s_sub_u32 s58, s56, s58
    s_lshl_b32 s59, s56, 10
    s_add_u32 s48, s59, 25165824
    s_lshl_b32 s57, s57, 6
    s_cmp_ge_u32 s58, 32
    s_cbranch_scc1 K1_TR8
    s_mul_i32 s58, s58, 25600
    s_add_u32 s58, s58, s57
    buffer_load_dwordx4 v7, s[12:15], s58 offen lds
    s_branch K1_TN8
K1_TR8:
    s_sub_u32 s58, s58, 32
    s_mul_i32 s58, s58, 102400
    s_add_u32 s58, s58, 20480
    s_add_u32 s58, s58, s57
    buffer_load_dwordx4 v8, s[12:15], s58 offen lds
K1_TN8:
    s_add_u32 s63, s63, 128
K1_TI8:
    s_mov_b32 s49, 0
    s_cmp_ge_u32 s63, 2960
    s_cbranch_scc1 K1_TI9
    s_add_u32 m0, s39, 9216
    s_cmp_lt_u32 s63, 2160
    s_cbranch_scc0 K1_TW9
    s_mul_hi_u32 s57, s63, 39768216
    s_mul_i32 s58, s57, 108
    s_sub_u32 s58, s63, s58
    s_lshl_b32 s59, s63, 10
    s_add_u32 s49, s59, 20971520
    s_mul_i32 s58, s58, 20480
    s_lshl_b32 s57, s57, 6
    s_add_u32 s58, s58, s57
    buffer_load_dwordx4 v7, s[8:11], s58 offen lds
    s_branch K1_TN9
K1_TW9:
    s_sub_u32 s56, s63, 2160
    s_mul_hi_u32 s57, s56, 107374183
    s_mul_i32 s58, s57, 40
    s_sub_u32 s58, s56, s58
    s_lshl_b32 s59, s56, 10
    s_add_u32 s49, s59, 25165824
    s_lshl_b32 s57, s57, 6
    s_cmp_ge_u32 s58, 32
    s_cbranch_scc1 K1_TR9
    s_mul_i32 s58, s58, 25600
    s_add_u32 s58, s58, s57
    buffer_load_dwordx4 v7, s[12:15], s58 offen lds
    s_branch K1_TN9
K1_TR9:
    s_sub_u32 s58, s58, 32
    s_mul_i32 s58, s58, 102400
    s_add_u32 s58, s58, 20480
    s_add_u32 s58, s58, s57
    buffer_load_dwordx4 v8, s[12:15], s58 offen lds
K1_TN9:
    s_add_u32 s63, s63, 128
K1_TI9:
    s_mov_b32 s50, 0
    s_cmp_ge_u32 s63, 2960
    s_cbranch_scc1 K1_TI10
    s_add_u32 m0, s39, 10240
    s_cmp_lt_u32 s63, 2160
    s_cbranch_scc0 K1_TW10
    s_mul_hi_u32 s57, s63, 39768216
    s_mul_i32 s58, s57, 108
    s_sub_u32 s58, s63, s58
    s_lshl_b32 s59, s63, 10
    s_add_u32 s50, s59, 20971520
    s_mul_i32 s58, s58, 20480
    s_lshl_b32 s57, s57, 6
    s_add_u32 s58, s58, s57
    buffer_load_dwordx4 v7, s[8:11], s58 offen lds
    s_branch K1_TN10
K1_TW10:
    s_sub_u32 s56, s63, 2160
    s_mul_hi_u32 s57, s56, 107374183
    s_mul_i32 s58, s57, 40
    s_sub_u32 s58, s56, s58
    s_lshl_b32 s59, s56, 10
    s_add_u32 s50, s59, 25165824
    s_lshl_b32 s57, s57, 6
    s_cmp_ge_u32 s58, 32
    s_cbranch_scc1 K1_TR10
    s_mul_i32 s58, s58, 25600
    s_add_u32 s58, s58, s57
    buffer_load_dwordx4 v7, s[12:15], s58 offen lds
    s_branch K1_TN10
K1_TR10:
    s_sub_u32 s58, s58, 32
    s_mul_i32 s58, s58, 102400
    s_add_u32 s58, s58, 20480
    s_add_u32 s58, s58, s57
    buffer_load_dwordx4 v8, s[12:15], s58 offen lds
K1_TN10:
    s_add_u32 s63, s63, 128
K1_TI10:
    s_mov_b32 s51, 0
    s_cmp_ge_u32 s63, 2960
    s_cbranch_scc1 K1_TI11
    s_add_u32 m0, s39, 11264
    s_cmp_lt_u32 s63, 2160
    s_cbranch_scc0 K1_TW11
    s_mul_hi_u32 s57, s63, 39768216
    s_mul_i32 s58, s57, 108
    s_sub_u32 s58, s63, s58
    s_lshl_b32 s59, s63, 10
    s_add_u32 s51, s59, 20971520
    s_mul_i32 s58, s58, 20480
    s_lshl_b32 s57, s57, 6
    s_add_u32 s58, s58, s57
    buffer_load_dwordx4 v7, s[8:11], s58 offen lds
    s_branch K1_TN11
K1_TW11:
    s_sub_u32 s56, s63, 2160
    s_mul_hi_u32 s57, s56, 107374183
    s_mul_i32 s58, s57, 40
    s_sub_u32 s58, s56, s58
    s_lshl_b32 s59, s56, 10
    s_add_u32 s51, s59, 25165824
    s_lshl_b32 s57, s57, 6
    s_cmp_ge_u32 s58, 32
    s_cbranch_scc1 K1_TR11
    s_mul_i32 s58, s58, 25600
    s_add_u32 s58, s58, s57
    buffer_load_dwordx4 v7, s[12:15], s58 offen lds
    s_branch K1_TN11
K1_TR11:
    s_sub_u32 s58, s58, 32
    s_mul_i32 s58, s58, 102400
    s_add_u32 s58, s58, 20480
    s_add_u32 s58, s58, s57
    buffer_load_dwordx4 v8, s[12:15], s58 offen lds
K1_TN11:
    s_add_u32 s63, s63, 128
K1_TI11:
    s_waitcnt vmcnt(0)
    ds_read_b64_tr_b16 v[16:17], v9 offset:0
    ds_read_b64_tr_b16 v[18:19], v9 offset:256
    ds_read_b64_tr_b16 v[20:21], v9 offset:1024
    ds_read_b64_tr_b16 v[22:23], v9 offset:1280
    ds_read_b64_tr_b16 v[24:25], v9 offset:2048
    ds_read_b64_tr_b16 v[26:27], v9 offset:2304
    ds_read_b64_tr_b16 v[28:29], v9 offset:3072
    ds_read_b64_tr_b16 v[30:31], v9 offset:3328
    ds_read_b64_tr_b16 v[32:33], v9 offset:4096
    ds_read_b64_tr_b16 v[34:35], v9 offset:4352
    ds_read_b64_tr_b16 v[36:37], v9 offset:5120
    ds_read_b64_tr_b16 v[38:39], v9 offset:5376
    ds_read_b64_tr_b16 v[40:41], v9 offset:6144
    ds_read_b64_tr_b16 v[42:43], v9 offset:6400
    ds_read_b64_tr_b16 v[44:45], v9 offset:7168
    ds_read_b64_tr_b16 v[46:47], v9 offset:7424
    ds_read_b64_tr_b16 v[48:49], v9 offset:8192
    ds_read_b64_tr_b16 v[50:51], v9 offset:8448
    ds_read_b64_tr_b16 v[52:53], v9 offset:9216
    ds_read_b64_tr_b16 v[54:55], v9 offset:9472
    ds_read_b64_tr_b16 v[56:57], v9 offset:10240
    ds_read_b64_tr_b16 v[58:59], v9 offset:10496
    ds_read_b64_tr_b16 v[60:61], v9 offset:11264
    ds_read_b64_tr_b16 v[62:63], v9 offset:11520
    s_waitcnt lgkmcnt(0)
    s_cmp_eq_u32 s40, 0
    s_cbranch_scc1 K1_TS0
    buffer_store_dwordx4 v[16:19], v10, s[16:19], s40 offen sc0 sc1
K1_TS0:
    s_cmp_eq_u32 s41, 0
    s_cbranch_scc1 K1_TS1
    buffer_store_dwordx4 v[20:23], v10, s[16:19], s41 offen sc0 sc1
K1_TS1:
    s_cmp_eq_u32 s42, 0
    s_cbranch_scc1 K1_TS2
    buffer_store_dwordx4 v[24:27], v10, s[16:19], s42 offen sc0 sc1
K1_TS2:
    s_cmp_eq_u32 s43, 0
    s_cbranch_scc1 K1_TS3
    buffer_store_dwordx4 v[28:31], v10, s[16:19], s43 offen sc0 sc1
K1_TS3:
    s_cmp_eq_u32 s44, 0
    s_cbranch_scc1 K1_TS4
    buffer_store_dwordx4 v[32:35], v10, s[16:19], s44 offen sc0 sc1
K1_TS4:
    s_cmp_eq_u32 s45, 0
    s_cbranch_scc1 K1_TS5
    buffer_store_dwordx4 v[36:39], v10, s[16:19], s45 offen sc0 sc1
K1_TS5:
    s_cmp_eq_u32 s46, 0
    s_cbranch_scc1 K1_TS6
    buffer_store_dwordx4 v[40:43], v10, s[16:19], s46 offen sc0 sc1
K1_TS6:
    s_cmp_eq_u32 s47, 0
    s_cbranch_scc1 K1_TS7
    buffer_store_dwordx4 v[44:47], v10, s[16:19], s47 offen sc0 sc1
K1_TS7:
    s_cmp_eq_u32 s48, 0
    s_cbranch_scc1 K1_TS8
    buffer_store_dwordx4 v[48:51], v10, s[16:19], s48 offen sc0 sc1
K1_TS8:
    s_cmp_eq_u32 s49, 0
    s_cbranch_scc1 K1_TS9
    buffer_store_dwordx4 v[52:55], v10, s[16:19], s49 offen sc0 sc1
K1_TS9:
    s_cmp_eq_u32 s50, 0
    s_cbranch_scc1 K1_TS10
    buffer_store_dwordx4 v[56:59], v10, s[16:19], s50 offen sc0 sc1
K1_TS10:
    s_cmp_eq_u32 s51, 0
    s_cbranch_scc1 K1_TS11
    buffer_store_dwordx4 v[60:63], v10, s[16:19], s51 offen sc0 sc1
K1_TS11:
    s_add_u32 s62, s62, 1
    s_cmp_lt_u32 s62, 2
    s_cbranch_scc1 K1_TB
K1_FIN:
K1_END:
    s_endpgm
.globl k2_kernel
.p2align 8
.type k2_kernel,@function
k2_kernel:
    s_cmp_ge_u32 s2, 256
    s_cbranch_scc1 K2_END
    s_load_dwordx2 s[24:25], s[0:1], 80
    s_load_dwordx2 s[6:7], s[0:1], 0
    v_and_b32 v1, 63, v0
    v_lshrrev_b32 v2, 6, v0
    s_and_b32 s36, s2, 31
    s_lshr_b32 s37, s2, 5
    v_readfirstlane_b32 s38, v2
    v_and_b32 v2, 31, v1
    v_lshrrev_b32 v3, 5, v1
    v_lshlrev_b32 v4, 4, v1
    v_lshlrev_b32 v5, 3, v2
    s_and_b32 s39, s38, 3
    s_lshr_b32 s40, s38, 2
    s_mul_i32 s41, s36, 81920
    s_waitcnt lgkmcnt(0)
    s_mov_b32 s16, s24
    s_mov_b32 s17, s25
    s_mov_b32 s18, 75497472
    s_mov_b32 s19, 0x00020000
    s_cmp_ge_u32 s38, 8
    s_cbranch_scc1 K2_MLP
    s_setprio 2
    s_lshl_b32 s42, s37, 3
    s_lshl_b32 s43, s39, 1
    s_add_u32 s42, s42, s43
    s_mul_i32 s42, s42, 1280
    s_add_u32 s42, s42, s41
    s_add_u32 s42, s42, 0
    buffer_load_dwordx4 v[96:99], v4, s[16:19], s42 offen
    buffer_load_dwordx2 v[100:101], v5, s[16:19], s42 offen offset:1024
    buffer_load_dwordx4 v[104:107], v4, s[16:19], s42 offen offset:1280
    buffer_load_dwordx2 v[108:109], v5, s[16:19], s42 offen offset:2304
    s_mul_i32 s43, s40, 40960
    s_add_u32 s43, s43, s41
    s_add_u32 s43, s43, 4194304
    buffer_load_dwordx4 v[112:115], v4, s[16:19], s43 offen
    buffer_load_dwordx2 v[116:117], v5, s[16:19], s43 offen offset:1024
    s_lshr_b32 s43, s38, 1
    s_and_b32 s44, s43, 1
    s_mul_i32 s44, s44, 40960
    s_and_b32 s45, s38, 1
    s_mul_i32 s45, s45, 5120
    s_add_u32 s44, s44, s45
    s_lshr_b32 s43, s43, 1
    s_mul_i32 s45, s43, 81920
    s_add_u32 s45, s45, s44
    s_cmp_eq_u32 s43, 1
    s_mov_b32 s46, 4194304
    s_cselect_b32 s46, 8388608, s46
    s_add_u32 s46, s46, s41
    s_add_u32 s46, s46, s44
    s_add_u32 m0, s45, 0
    s_add_u32 s47, s46, 0
    buffer_load_dwordx4 v4, s[16:19], s47 offen lds
    buffer_load_dwordx4 v4, s[16:19], s47 offen offset:1024 lds
    buffer_load_dwordx4 v4, s[16:19], s47 offen offset:2048 lds
    buffer_load_dwordx4 v4, s[16:19], s47 offen offset:3072 lds
    s_add_u32 m0, s45, 4096
    s_add_u32 s47, s46, 4096
    buffer_load_dwordx4 v4, s[16:19], s47 offen lds
    s_mul_i32 s43, s40, 40960
    v_add_u32 v8, s43, v4
    v_add_u32 v9, s43, v5
    v_add_u32 v9, 1024, v9
    v_mul_u32_u24 v6, 320, v3
    v_lshl_add_u32 v6, v2, 4, v6
    s_add_u32 s43, s43, 81920
    v_add_u32 v10, s43, v6
    v_mov_b32 v14, v8
    v_mov_b32 v15, v9
    v_mov_b32 v11, v10
    v_cmp_gt_u32 vcc, 20, v2
    s_mov_b64 s[48:49], vcc
    v_cmp_eq_u32 vcc, 0, v3
    s_mov_b64 s[50:51], vcc
    v_mov_b32 v128, 0
    v_mov_b32 v129, 0
    v_mov_b32 v130, 0
    v_mov_b32 v131, 0
    v_mov_b32 v132, 0
    v_mov_b32 v133, 0
    v_mov_b32 v134, 0
    v_mov_b32 v135, 0
    v_mov_b32 v136, 0
    v_mov_b32 v137, 0
    v_mov_b32 v138, 0
    v_mov_b32 v139, 0
    v_mov_b32 v140, 0
    v_mov_b32 v141, 0
    v_mov_b32 v142, 0
    v_mov_b32 v143, 0
    s_mov_b32 exec_lo, 0x11000000
    s_mov_b32 exec_hi, 0x11000000
    v_mov_b32 v128, 0x3f803f80
    v_mov_b32 v129, 0x3f803f80
    v_mov_b32 v130, 0x3f803f80
    v_mov_b32 v131, 0x3f803f80
    v_mov_b32 v132, 0x3f803f80
    v_mov_b32 v133, 0x3f803f80
    v_mov_b32 v134, 0x3f803f80
    v_mov_b32 v135, 0x3f803f80
    v_mov_b32 v136, 0x3f803f80
    v_mov_b32 v137, 0x3f803f80
    v_mov_b32 v138, 0x3f803f80
    v_mov_b32 v139, 0x3f803f80
    v_mov_b32 v140, 0x3f803f80
    v_mov_b32 v141, 0x3f803f80
    v_mov_b32 v142, 0x3f803f80
    v_mov_b32 v143, 0x3f803f80
    s_mov_b64 exec, -1
    v_mov_b32 v124, 0x3f803f80
    v_mov_b32 v125, 0x00003f80
    s_mov_b32 s52, 0
    v_mov_b32 v64, 0
    v_mov_b32 v65, 0
    v_mov_b32 v66, 0
    v_mov_b32 v67, 0
    v_mov_b32 v68, 0
    v_mov_b32 v69, 0
    v_mov_b32 v70, 0
    v_mov_b32 v71, 0
    v_mov_b32 v72, 0
    v_mov_b32 v73, 0
    v_mov_b32 v74, 0
    v_mov_b32 v75, 0
    v_mov_b32 v76, 0
    v_mov_b32 v77, 0
    v_mov_b32 v78, 0
    v_mov_b32 v79, 0
    v_mov_b32 v80, 0
    v_mov_b32 v81, 0
    v_mov_b32 v82, 0
    v_mov_b32 v83, 0
    v_mov_b32 v84, 0
    v_mov_b32 v85, 0
    v_mov_b32 v86, 0
    v_mov_b32 v87, 0
    v_mov_b32 v88, 0
    v_mov_b32 v89, 0
    v_mov_b32 v90, 0
    v_mov_b32 v91, 0
    v_mov_b32 v92, 0
    v_mov_b32 v93, 0
    v_mov_b32 v94, 0
    v_mov_b32 v95, 0
    s_waitcnt vmcnt(5)
    s_mov_b64 exec, s[50:51]
    s_not_b64 exec, exec
    v_mov_b32 v100, 0
    v_mov_b32 v101, 0
    v_mov_b32 v108, 0
    v_mov_b32 v109, 0
    v_mov_b32 v116, 0x3f803f80
    v_mov_b32 v117, 0x00003f80
    s_mov_b64 exec, -1
    v_mov_b32 v102, 0
    v_mov_b32 v103, 0
    v_mov_b32 v110, 0
    v_mov_b32 v111, 0
    s_nop 1
    v_mfma_f32_32x32x16_bf16 v[16:31], v[112:115], v[96:99], 0
    v_mfma_f32_32x32x8bf16_1k v[16:31], v[116:117], v[100:101], v[16:31]
    v_mfma_f32_32x32x16_bf16 v[32:47], v[112:115], v[104:107], 0
    v_mfma_f32_32x32x8bf16_1k v[32:47], v[116:117], v[108:109], v[32:47]
    s_nop 15
    v_max3_f32 v144, v16, v17, v18
    v_max3_f32 v144, v144, v19, v20
    v_max3_f32 v144, v144, v21, v22
    v_max3_f32 v144, v144, v23, v24
    v_max3_f32 v144, v144, v25, v26
    v_max3_f32 v144, v144, v27, v28
    v_max3_f32 v144, v144, v29, v30
    v_max_f32 v144, v144, v31
    v_max3_f32 v145, v32, v33, v34
    v_max3_f32 v145, v145, v35, v36
    v_max3_f32 v145, v145, v37, v38
    v_max3_f32 v145, v145, v39, v40
    v_max3_f32 v145, v145, v41, v42
    v_max3_f32 v145, v145, v43, v44
    v_max3_f32 v145, v145, v45, v46
    v_max_f32 v145, v145, v47
K2_SETM:
    v_mov_b32 v146, v144
    s_nop 1
    v_permlane32_swap_b32 v144, v146
    s_nop 1
    v_max_f32 v144, v144, v146
    v_cvt_pk_bf16_f32 v147, v144, v144
    v_lshlrev_b32 v147, 16, v147
    v_sub_f32 v148, v144, v147
    v_cvt_pk_bf16_f32 v149, v148, v148
    v_lshlrev_b32 v149, 16, v149
    v_sub_f32 v148, v148, v149
    v_cvt_pk_bf16_f32 v150, v148, v148
    v_lshlrev_b32 v150, 16, v150
    v_add_f32 v12, v147, v149
    v_add_f32 v12, v12, v150
    v_cvt_pk_bf16_f32 v147, -v147, -v149
    v_mov_b32 v151, 0
    v_cvt_pk_bf16_f32 v150, -v150, v151
    s_mov_b64 exec, s[50:51]
    s_not_b64 exec, exec
    v_mov_b32 v100, v147
    v_mov_b32 v101, v150
    s_mov_b64 exec, -1
    v_mov_b32 v146, v145
    s_nop 1
    v_permlane32_swap_b32 v145, v146
    s_nop 1
    v_max_f32 v145, v145, v146
    v_cvt_pk_bf16_f32 v147, v145, v145
    v_lshlrev_b32 v147, 16, v147
    v_sub_f32 v148, v145, v147
    v_cvt_pk_bf16_f32 v149, v148, v148
    v_lshlrev_b32 v149, 16, v149
    v_sub_f32 v148, v148, v149
    v_cvt_pk_bf16_f32 v150, v148, v148
    v_lshlrev_b32 v150, 16, v150
    v_add_f32 v13, v147, v149
    v_add_f32 v13, v13, v150
    v_cvt_pk_bf16_f32 v147, -v147, -v149
    v_mov_b32 v151, 0
    v_cvt_pk_bf16_f32 v150, -v150, v151
    s_mov_b64 exec, s[50:51]
    s_not_b64 exec, exec
    v_mov_b32 v108, v147
    v_mov_b32 v109, v150
    s_mov_b64 exec, -1
    s_cmp_eq_u32 s52, 0
    s_cbranch_scc1 K2_FIRST
    v_mov_b32 v64, 0
    v_mov_b32 v65, 0
    v_mov_b32 v66, 0
    v_mov_b32 v67, 0
    v_mov_b32 v68, 0
    v_mov_b32 v69, 0
    v_mov_b32 v70, 0
    v_mov_b32 v71, 0
    v_mov_b32 v72, 0
    v_mov_b32 v73, 0
    v_mov_b32 v74, 0
    v_mov_b32 v75, 0
    v_mov_b32 v76, 0
    v_mov_b32 v77, 0
    v_mov_b32 v78, 0
    v_mov_b32 v79, 0
    v_mov_b32 v80, 0
    v_mov_b32 v81, 0
    v_mov_b32 v82, 0
    v_mov_b32 v83, 0
    v_mov_b32 v84, 0
    v_mov_b32 v85, 0
    v_mov_b32 v86, 0
    v_mov_b32 v87, 0
    v_mov_b32 v88, 0
    v_mov_b32 v89, 0
    v_mov_b32 v90, 0
    v_mov_b32 v91, 0
    v_mov_b32 v92, 0
    v_mov_b32 v93, 0
    v_mov_b32 v94, 0
    v_mov_b32 v95, 0
    v_mov_b32 v8, v14
    v_mov_b32 v9, v15
    v_mov_b32 v10, v11
    ds_read_b128 v[112:115], v8 offset:0
    s_mov_b64 exec, s[50:51]
    ds_read_b64 v[116:117], v9 offset:0
    s_mov_b64 exec, -1
    s_mov_b64 exec, s[48:49]
    ds_read_b128 v[128:131], v10 offset:0
    ds_read_b128 v[132:135], v10 offset:640
    s_mov_b64 exec, -1
    s_waitcnt lgkmcnt(0)
    s_branch K2_GO
K2_FIRST:
    s_waitcnt vmcnt(0)
    s_barrier
    s_mov_b64 exec, s[48:49]
    ds_read_b128 v[128:131], v10 offset:0
    ds_read_b128 v[132:135], v10 offset:640
    s_mov_b64 exec, -1
K2_GO:
    s_mov_b32 s53, 0
    s_nop 1
    v_mfma_f32_32x32x16_bf16 v[16:31], v[112:115], v[96:99], 0
    v_mfma_f32_32x32x8bf16_1k v[16:31], v[116:117], v[100:101], v[16:31]
K2_CHUNK:
    ds_read_b128 v[120:123], v8 offset:1280
    s_mov_b64 exec, s[50:51]
    ds_read_b64 v[124:125], v9 offset:1280
    s_mov_b64 exec, -1
    s_waitcnt lgkmcnt(2)
    v_mfma_f32_32x32x16_bf16 v[32:47], v[112:115], v[104:107], 0
    v_exp_f32 v16, v16
    v_exp_f32 v17, v17
    v_exp_f32 v18, v18
    v_exp_f32 v19, v19
    v_cvt_pk_bf16_f32 v48, v16, v17
    v_mfma_f32_32x32x8bf16_1k v[32:47], v[116:117], v[108:109], v[32:47]
    v_exp_f32 v20, v20
    v_exp_f32 v21, v21
    v_cvt_pk_bf16_f32 v49, v18, v19
    v_exp_f32 v22, v22
    v_exp_f32 v23, v23
    v_cvt_pk_bf16_f32 v50, v20, v21
    v_exp_f32 v24, v24
    v_exp_f32 v25, v25
    v_cvt_pk_bf16_f32 v51, v22, v23
    v_exp_f32 v26, v26
    v_exp_f32 v27, v27
    v_mfma_f32_32x32x16_bf16 v[64:79], v[128:131], v[48:51], v[64:79]
    v_cvt_pk_bf16_f32 v52, v24, v25
    v_exp_f32 v28, v28
    v_exp_f32 v29, v29
    v_cvt_pk_bf16_f32 v53, v26, v27
    v_exp_f32 v30, v30
    v_exp_f32 v31, v31
    v_cvt_pk_bf16_f32 v54, v28, v29
    s_nop 0
    v_cvt_pk_bf16_f32 v55, v30, v31
    s_nop 1
    v_mfma_f32_32x32x16_bf16 v[64:79], v[132:135], v[52:55], v[64:79]
    s_waitcnt lgkmcnt(0)
    s_mov_b64 exec, s[48:49]
    ds_read_b128 v[136:139], v10 offset:1280
    ds_read_b128 v[140:143], v10 offset:1920
    s_mov_b64 exec, -1
    v_mfma_f32_32x32x16_bf16 v[16:31], v[120:123], v[96:99], 0
    v_exp_f32 v32, v32
    v_exp_f32 v33, v33
    v_exp_f32 v34, v34
    v_exp_f32 v35, v35
    v_cvt_pk_bf16_f32 v56, v32, v33
    v_mfma_f32_32x32x8bf16_1k v[16:31], v[124:125], v[100:101], v[16:31]
    v_exp_f32 v36, v36
    v_exp_f32 v37, v37
    v_cvt_pk_bf16_f32 v57, v34, v35
    v_exp_f32 v38, v38
    v_exp_f32 v39, v39
    v_cvt_pk_bf16_f32 v58, v36, v37
    v_exp_f32 v40, v40
    v_exp_f32 v41, v41
    v_cvt_pk_bf16_f32 v59, v38, v39
    v_exp_f32 v42, v42
    v_exp_f32 v43, v43
    v_mfma_f32_32x32x16_bf16 v[80:95], v[128:131], v[56:59], v[80:95]
    v_cvt_pk_bf16_f32 v60, v40, v41
    v_exp_f32 v44, v44
    v_exp_f32 v45, v45
    v_cvt_pk_bf16_f32 v61, v42, v43
    v_exp_f32 v46, v46
    v_exp_f32 v47, v47
    v_cvt_pk_bf16_f32 v62, v44, v45
    s_nop 0
    v_cvt_pk_bf16_f32 v63, v46, v47
    s_nop 1
    v_mfma_f32_32x32x16_bf16 v[80:95], v[132:135], v[60:63], v[80:95]
    ds_read_b128 v[112:115], v8 offset:2560
    s_mov_b64 exec, s[50:51]
    ds_read_b64 v[116:117], v9 offset:2560
    s_mov_b64 exec, -1
    s_waitcnt lgkmcnt(2)
    v_mfma_f32_32x32x16_bf16 v[32:47], v[120:123], v[104:107], 0
    v_exp_f32 v16, v16
    v_exp_f32 v17, v17
    v_exp_f32 v18, v18
    v_exp_f32 v19, v19
    v_cvt_pk_bf16_f32 v48, v16, v17
    v_mfma_f32_32x32x8bf16_1k v[32:47], v[124:125], v[108:109], v[32:47]
    v_exp_f32 v20, v20
    v_exp_f32 v21, v21
    v_cvt_pk_bf16_f32 v49, v18, v19
    v_exp_f32 v22, v22
    v_exp_f32 v23, v23
    v_cvt_pk_bf16_f32 v50, v20, v21
    v_exp_f32 v24, v24
    v_exp_f32 v25, v25
    v_cvt_pk_bf16_f32 v51, v22, v23
    v_exp_f32 v26, v26
    v_exp_f32 v27, v27
    v_mfma_f32_32x32x16_bf16 v[64:79], v[136:139], v[48:51], v[64:79]
    v_cvt_pk_bf16_f32 v52, v24, v25
    v_exp_f32 v28, v28
    v_exp_f32 v29, v29
    v_cvt_pk_bf16_f32 v53, v26, v27
    v_exp_f32 v30, v30
    v_exp_f32 v31, v31
    v_cvt_pk_bf16_f32 v54, v28, v29
    s_nop 0
    v_cvt_pk_bf16_f32 v55, v30, v31
    s_nop 1
    v_mfma_f32_32x32x16_bf16 v[64:79], v[140:143], v[52:55], v[64:79]
    s_waitcnt lgkmcnt(0)
    s_mov_b64 exec, s[48:49]
    ds_read_b128 v[128:131], v10 offset:2560
    ds_read_b128 v[132:135], v10 offset:3200
    s_mov_b64 exec, -1
    v_mfma_f32_32x32x16_bf16 v[16:31], v[112:115], v[96:99], 0
    v_exp_f32 v32, v32
    v_exp_f32 v33, v33
    v_exp_f32 v34, v34
    v_exp_f32 v35, v35
    v_cvt_pk_bf16_f32 v56, v32, v33
    v_mfma_f32_32x32x8bf16_1k v[16:31], v[116:117], v[100:101], v[16:31]
    v_exp_f32 v36, v36
    v_exp_f32 v37, v37
    v_cvt_pk_bf16_f32 v57, v34, v35
    v_exp_f32 v38, v38
    v_exp_f32 v39, v39
    v_cvt_pk_bf16_f32 v58, v36, v37
    v_exp_f32 v40, v40
    v_exp_f32 v41, v41
    v_cvt_pk_bf16_f32 v59, v38, v39
    v_exp_f32 v42, v42
    v_exp_f32 v43, v43
    v_mfma_f32_32x32x16_bf16 v[80:95], v[136:139], v[56:59], v[80:95]
    v_cvt_pk_bf16_f32 v60, v40, v41
    v_exp_f32 v44, v44
    v_exp_f32 v45, v45
    v_cvt_pk_bf16_f32 v61, v42, v43
    v_exp_f32 v46, v46
    v_exp_f32 v47, v47
    v_cvt_pk_bf16_f32 v62, v44, v45
    s_nop 0
    v_cvt_pk_bf16_f32 v63, v46, v47
    s_nop 1
    v_mfma_f32_32x32x16_bf16 v[80:95], v[140:143], v[60:63], v[80:95]
    ds_read_b128 v[120:123], v8 offset:3840
    s_mov_b64 exec, s[50:51]
    ds_read_b64 v[124:125], v9 offset:3840
    s_mov_b64 exec, -1
    s_waitcnt lgkmcnt(2)
    v_mfma_f32_32x32x16_bf16 v[32:47], v[112:115], v[104:107], 0
    v_exp_f32 v16, v16
    v_exp_f32 v17, v17
    v_exp_f32 v18, v18
    v_exp_f32 v19, v19
    v_cvt_pk_bf16_f32 v48, v16, v17
    v_mfma_f32_32x32x8bf16_1k v[32:47], v[116:117], v[108:109], v[32:47]
    v_exp_f32 v20, v20
    v_exp_f32 v21, v21
    v_cvt_pk_bf16_f32 v49, v18, v19
    v_exp_f32 v22, v22
    v_exp_f32 v23, v23
    v_cvt_pk_bf16_f32 v50, v20, v21
    v_exp_f32 v24, v24
    v_exp_f32 v25, v25
    v_cvt_pk_bf16_f32 v51, v22, v23
    v_exp_f32 v26, v26
    v_exp_f32 v27, v27
    v_mfma_f32_32x32x16_bf16 v[64:79], v[128:131], v[48:51], v[64:79]
    v_cvt_pk_bf16_f32 v52, v24, v25
    v_exp_f32 v28, v28
    v_exp_f32 v29, v29
    v_cvt_pk_bf16_f32 v53, v26, v27
    v_exp_f32 v30, v30
    v_exp_f32 v31, v31
    v_cvt_pk_bf16_f32 v54, v28, v29
    s_nop 0
    v_cvt_pk_bf16_f32 v55, v30, v31
    s_nop 1
    v_mfma_f32_32x32x16_bf16 v[64:79], v[132:135], v[52:55], v[64:79]
    s_waitcnt lgkmcnt(0)
    s_mov_b64 exec, s[48:49]
    ds_read_b128 v[136:139], v10 offset:3840
    ds_read_b128 v[140:143], v10 offset:4480
    s_mov_b64 exec, -1
    v_mfma_f32_32x32x16_bf16 v[16:31], v[120:123], v[96:99], 0
    v_exp_f32 v32, v32
    v_exp_f32 v33, v33
    v_exp_f32 v34, v34
    v_exp_f32 v35, v35
    v_cvt_pk_bf16_f32 v56, v32, v33
    v_mfma_f32_32x32x8bf16_1k v[16:31], v[124:125], v[100:101], v[16:31]
    v_exp_f32 v36, v36
    v_exp_f32 v37, v37
    v_cvt_pk_bf16_f32 v57, v34, v35
    v_exp_f32 v38, v38
    v_exp_f32 v39, v39
    v_cvt_pk_bf16_f32 v58, v36, v37
    v_exp_f32 v40, v40
    v_exp_f32 v41, v41
    v_cvt_pk_bf16_f32 v59, v38, v39
    v_exp_f32 v42, v42
    v_exp_f32 v43, v43
    v_mfma_f32_32x32x16_bf16 v[80:95], v[128:131], v[56:59], v[80:95]
    v_cvt_pk_bf16_f32 v60, v40, v41
    v_exp_f32 v44, v44
    v_exp_f32 v45, v45
    v_cvt_pk_bf16_f32 v61, v42, v43
    v_exp_f32 v46, v46
    v_exp_f32 v47, v47
    v_cvt_pk_bf16_f32 v62, v44, v45
    s_nop 0
    v_cvt_pk_bf16_f32 v63, v46, v47
    s_nop 1
    v_mfma_f32_32x32x16_bf16 v[80:95], v[132:135], v[60:63], v[80:95]
    ds_read_b128 v[112:115], v8 offset:5120
    s_mov_b64 exec, s[50:51]
    ds_read_b64 v[116:117], v9 offset:5120
    s_mov_b64 exec, -1
    s_waitcnt lgkmcnt(2)
    v_mfma_f32_32x32x16_bf16 v[32:47], v[120:123], v[104:107], 0
    v_exp_f32 v16, v16
    v_exp_f32 v17, v17
    v_exp_f32 v18, v18
    v_exp_f32 v19, v19
    v_cvt_pk_bf16_f32 v48, v16, v17
    v_mfma_f32_32x32x8bf16_1k v[32:47], v[124:125], v[108:109], v[32:47]
    v_exp_f32 v20, v20
    v_exp_f32 v21, v21
    v_cvt_pk_bf16_f32 v49, v18, v19
    v_exp_f32 v22, v22
    v_exp_f32 v23, v23
    v_cvt_pk_bf16_f32 v50, v20, v21
    v_exp_f32 v24, v24
    v_exp_f32 v25, v25
    v_cvt_pk_bf16_f32 v51, v22, v23
    v_exp_f32 v26, v26
    v_exp_f32 v27, v27
    v_mfma_f32_32x32x16_bf16 v[64:79], v[136:139], v[48:51], v[64:79]
    v_cvt_pk_bf16_f32 v52, v24, v25
    v_exp_f32 v28, v28
    v_exp_f32 v29, v29
    v_cvt_pk_bf16_f32 v53, v26, v27
    v_exp_f32 v30, v30
    v_exp_f32 v31, v31
    v_cvt_pk_bf16_f32 v54, v28, v29
    s_nop 0
    v_cvt_pk_bf16_f32 v55, v30, v31
    s_nop 1
    v_mfma_f32_32x32x16_bf16 v[64:79], v[140:143], v[52:55], v[64:79]
    s_waitcnt lgkmcnt(0)
    s_mov_b64 exec, s[48:49]
    ds_read_b128 v[128:131], v10 offset:5120
    ds_read_b128 v[132:135], v10 offset:5760
    s_mov_b64 exec, -1
    v_mfma_f32_32x32x16_bf16 v[16:31], v[112:115], v[96:99], 0
    v_exp_f32 v32, v32
    v_exp_f32 v33, v33
    v_exp_f32 v34, v34
    v_exp_f32 v35, v35
    v_cvt_pk_bf16_f32 v56, v32, v33
    v_mfma_f32_32x32x8bf16_1k v[16:31], v[116:117], v[100:101], v[16:31]
    v_exp_f32 v36, v36
    v_exp_f32 v37, v37
    v_cvt_pk_bf16_f32 v57, v34, v35
    v_exp_f32 v38, v38
    v_exp_f32 v39, v39
    v_cvt_pk_bf16_f32 v58, v36, v37
    v_exp_f32 v40, v40
    v_exp_f32 v41, v41
    v_cvt_pk_bf16_f32 v59, v38, v39
    v_exp_f32 v42, v42
    v_exp_f32 v43, v43
    v_mfma_f32_32x32x16_bf16 v[80:95], v[136:139], v[56:59], v[80:95]
    v_cvt_pk_bf16_f32 v60, v40, v41
    v_exp_f32 v44, v44
    v_exp_f32 v45, v45
    v_cvt_pk_bf16_f32 v61, v42, v43
    v_exp_f32 v46, v46
    v_exp_f32 v47, v47
    v_cvt_pk_bf16_f32 v62, v44, v45
    s_nop 0
    v_cvt_pk_bf16_f32 v63, v46, v47
    s_nop 1
    v_mfma_f32_32x32x16_bf16 v[80:95], v[140:143], v[60:63], v[80:95]
    ds_read_b128 v[120:123], v8 offset:6400
    s_mov_b64 exec, s[50:51]
    ds_read_b64 v[124:125], v9 offset:6400
    s_mov_b64 exec, -1
    s_waitcnt lgkmcnt(2)
    v_mfma_f32_32x32x16_bf16 v[32:47], v[112:115], v[104:107], 0
    v_exp_f32 v16, v16
    v_exp_f32 v17, v17
    v_exp_f32 v18, v18
    v_exp_f32 v19, v19
    v_cvt_pk_bf16_f32 v48, v16, v17
    v_mfma_f32_32x32x8bf16_1k v[32:47], v[116:117], v[108:109], v[32:47]
    v_exp_f32 v20, v20
    v_exp_f32 v21, v21
    v_cvt_pk_bf16_f32 v49, v18, v19
    v_exp_f32 v22, v22
    v_exp_f32 v23, v23
    v_cvt_pk_bf16_f32 v50, v20, v21
    v_exp_f32 v24, v24
    v_exp_f32 v25, v25
    v_cvt_pk_bf16_f32 v51, v22, v23
    v_exp_f32 v26, v26
    v_exp_f32 v27, v27
    v_mfma_f32_32x32x16_bf16 v[64:79], v[128:131], v[48:51], v[64:79]
    v_cvt_pk_bf16_f32 v52, v24, v25
    v_exp_f32 v28, v28
    v_exp_f32 v29, v29
    v_cvt_pk_bf16_f32 v53, v26, v27
    v_exp_f32 v30, v30
    v_exp_f32 v31, v31
    v_cvt_pk_bf16_f32 v54, v28, v29
    s_nop 0
    v_cvt_pk_bf16_f32 v55, v30, v31
    s_nop 1
    v_mfma_f32_32x32x16_bf16 v[64:79], v[132:135], v[52:55], v[64:79]
    s_waitcnt lgkmcnt(0)
    s_mov_b64 exec, s[48:49]
    ds_read_b128 v[136:139], v10 offset:6400
    ds_read_b128 v[140:143], v10 offset:7040
    s_mov_b64 exec, -1
    v_mfma_f32_32x32x16_bf16 v[16:31], v[120:123], v[96:99], 0
    v_exp_f32 v32, v32
    v_exp_f32 v33, v33
    v_exp_f32 v34, v34
    v_exp_f32 v35, v35
    v_cvt_pk_bf16_f32 v56, v32, v33
    v_mfma_f32_32x32x8bf16_1k v[16:31], v[124:125], v[100:101], v[16:31]
    v_exp_f32 v36, v36
    v_exp_f32 v37, v37
    v_cvt_pk_bf16_f32 v57, v34, v35
    v_exp_f32 v38, v38
    v_exp_f32 v39, v39
    v_cvt_pk_bf16_f32 v58, v36, v37
    v_exp_f32 v40, v40
    v_exp_f32 v41, v41
    v_cvt_pk_bf16_f32 v59, v38, v39
    v_exp_f32 v42, v42
    v_exp_f32 v43, v43
    v_mfma_f32_32x32x16_bf16 v[80:95], v[128:131], v[56:59], v[80:95]
    v_cvt_pk_bf16_f32 v60, v40, v41
    v_exp_f32 v44, v44
    v_exp_f32 v45, v45
    v_cvt_pk_bf16_f32 v61, v42, v43
    v_exp_f32 v46, v46
    v_exp_f32 v47, v47
    v_cvt_pk_bf16_f32 v62, v44, v45
    s_nop 0
    v_cvt_pk_bf16_f32 v63, v46, v47
    s_nop 1
    v_mfma_f32_32x32x16_bf16 v[80:95], v[132:135], v[60:63], v[80:95]
    ds_read_b128 v[112:115], v8 offset:7680
    s_mov_b64 exec, s[50:51]
    ds_read_b64 v[116:117], v9 offset:7680
    s_mov_b64 exec, -1
    s_waitcnt lgkmcnt(2)
    v_mfma_f32_32x32x16_bf16 v[32:47], v[120:123], v[104:107], 0
    v_exp_f32 v16, v16
    v_exp_f32 v17, v17
    v_exp_f32 v18, v18
    v_exp_f32 v19, v19
    v_cvt_pk_bf16_f32 v48, v16, v17
    v_mfma_f32_32x32x8bf16_1k v[32:47], v[124:125], v[108:109], v[32:47]
    v_exp_f32 v20, v20
    v_exp_f32 v21, v21
    v_cvt_pk_bf16_f32 v49, v18, v19
    v_exp_f32 v22, v22
    v_exp_f32 v23, v23
    v_cvt_pk_bf16_f32 v50, v20, v21
    v_exp_f32 v24, v24
    v_exp_f32 v25, v25
    v_cvt_pk_bf16_f32 v51, v22, v23
    v_exp_f32 v26, v26
    v_exp_f32 v27, v27
    v_mfma_f32_32x32x16_bf16 v[64:79], v[136:139], v[48:51], v[64:79]
    v_cvt_pk_bf16_f32 v52, v24, v25
    v_exp_f32 v28, v28
    v_exp_f32 v29, v29
    v_cvt_pk_bf16_f32 v53, v26, v27
    v_exp_f32 v30, v30
    v_exp_f32 v31, v31
    v_cvt_pk_bf16_f32 v54, v28, v29
    s_nop 0
    v_cvt_pk_bf16_f32 v55, v30, v31
    s_nop 1
    v_mfma_f32_32x32x16_bf16 v[64:79], v[140:143], v[52:55], v[64:79]
    s_waitcnt lgkmcnt(0)
    s_mov_b64 exec, s[48:49]
    ds_read_b128 v[128:131], v10 offset:7680
    ds_read_b128 v[132:135], v10 offset:8320
    s_mov_b64 exec, -1
    v_mfma_f32_32x32x16_bf16 v[16:31], v[112:115], v[96:99], 0
    v_exp_f32 v32, v32
    v_exp_f32 v33, v33
    v_exp_f32 v34, v34
    v_exp_f32 v35, v35
    v_cvt_pk_bf16_f32 v56, v32, v33
    v_mfma_f32_32x32x8bf16_1k v[16:31], v[116:117], v[100:101], v[16:31]
    v_exp_f32 v36, v36
    v_exp_f32 v37, v37
    v_cvt_pk_bf16_f32 v57, v34, v35
    v_exp_f32 v38, v38
    v_exp_f32 v39, v39
    v_cvt_pk_bf16_f32 v58, v36, v37
    v_exp_f32 v40, v40
    v_exp_f32 v41, v41
    v_cvt_pk_bf16_f32 v59, v38, v39
    v_exp_f32 v42, v42
    v_exp_f32 v43, v43
    v_mfma_f32_32x32x16_bf16 v[80:95], v[136:139], v[56:59], v[80:95]
    v_cvt_pk_bf16_f32 v60, v40, v41
    v_exp_f32 v44, v44
    v_exp_f32 v45, v45
    v_cvt_pk_bf16_f32 v61, v42, v43
    v_exp_f32 v46, v46
    v_exp_f32 v47, v47
    v_cvt_pk_bf16_f32 v62, v44, v45
    s_nop 0
    v_cvt_pk_bf16_f32 v63, v46, v47
    s_nop 1
    v_mfma_f32_32x32x16_bf16 v[80:95], v[140:143], v[60:63], v[80:95]
    ds_read_b128 v[120:123], v8 offset:8960
    s_mov_b64 exec, s[50:51]
    ds_read_b64 v[124:125], v9 offset:8960
    s_mov_b64 exec, -1
    s_waitcnt lgkmcnt(2)
    v_mfma_f32_32x32x16_bf16 v[32:47], v[112:115], v[104:107], 0
    v_exp_f32 v16, v16
    v_exp_f32 v17, v17
    v_exp_f32 v18, v18
    v_exp_f32 v19, v19
    v_cvt_pk_bf16_f32 v48, v16, v17
    v_mfma_f32_32x32x8bf16_1k v[32:47], v[116:117], v[108:109], v[32:47]
    v_exp_f32 v20, v20
    v_exp_f32 v21, v21
    v_cvt_pk_bf16_f32 v49, v18, v19
    v_exp_f32 v22, v22
    v_exp_f32 v23, v23
    v_cvt_pk_bf16_f32 v50, v20, v21
    v_exp_f32 v24, v24
    v_exp_f32 v25, v25
    v_cvt_pk_bf16_f32 v51, v22, v23
    v_exp_f32 v26, v26
    v_exp_f32 v27, v27
    v_mfma_f32_32x32x16_bf16 v[64:79], v[128:131], v[48:51], v[64:79]
    v_cvt_pk_bf16_f32 v52, v24, v25
    v_exp_f32 v28, v28
    v_exp_f32 v29, v29
    v_cvt_pk_bf16_f32 v53, v26, v27
    v_exp_f32 v30, v30
    v_exp_f32 v31, v31
    v_cvt_pk_bf16_f32 v54, v28, v29
    s_nop 0
    v_cvt_pk_bf16_f32 v55, v30, v31
    s_nop 1
    v_mfma_f32_32x32x16_bf16 v[64:79], v[132:135], v[52:55], v[64:79]
    s_waitcnt lgkmcnt(0)
    s_mov_b64 exec, s[48:49]
    ds_read_b128 v[136:139], v10 offset:8960
    ds_read_b128 v[140:143], v10 offset:9600
    s_mov_b64 exec, -1
    v_mfma_f32_32x32x16_bf16 v[16:31], v[120:123], v[96:99], 0
    v_exp_f32 v32, v32
    v_exp_f32 v33, v33
    v_exp_f32 v34, v34
    v_exp_f32 v35, v35
    v_cvt_pk_bf16_f32 v56, v32, v33
    v_mfma_f32_32x32x8bf16_1k v[16:31], v[124:125], v[100:101], v[16:31]
    v_exp_f32 v36, v36
    v_exp_f32 v37, v37
    v_cvt_pk_bf16_f32 v57, v34, v35
    v_exp_f32 v38, v38
    v_exp_f32 v39, v39
    v_cvt_pk_bf16_f32 v58, v36, v37
    v_exp_f32 v40, v40
    v_exp_f32 v41, v41
    v_cvt_pk_bf16_f32 v59, v38, v39
    v_exp_f32 v42, v42
    v_exp_f32 v43, v43
    v_mfma_f32_32x32x16_bf16 v[80:95], v[128:131], v[56:59], v[80:95]
    v_cvt_pk_bf16_f32 v60, v40, v41
    v_exp_f32 v44, v44
    v_exp_f32 v45, v45
    v_cvt_pk_bf16_f32 v61, v42, v43
    v_exp_f32 v46, v46
    v_exp_f32 v47, v47
    v_cvt_pk_bf16_f32 v62, v44, v45
    s_nop 0
    v_cvt_pk_bf16_f32 v63, v46, v47
    s_nop 1
    v_mfma_f32_32x32x16_bf16 v[80:95], v[132:135], v[60:63], v[80:95]
    s_cmp_lg_u32 s52, 0
    s_cbranch_scc1 K2_NOBAR
    s_barrier
K2_NOBAR:
    ds_read_b128 v[112:115], v8 offset:10240
    s_mov_b64 exec, s[50:51]
    ds_read_b64 v[116:117], v9 offset:10240
    s_mov_b64 exec, -1
    s_waitcnt lgkmcnt(2)
    v_mfma_f32_32x32x16_bf16 v[32:47], v[120:123], v[104:107], 0
    v_exp_f32 v16, v16
    v_exp_f32 v17, v17
    v_exp_f32 v18, v18
    v_exp_f32 v19, v19
    v_cvt_pk_bf16_f32 v48, v16, v17
    v_mfma_f32_32x32x8bf16_1k v[32:47], v[124:125], v[108:109], v[32:47]
    v_exp_f32 v20, v20
    v_exp_f32 v21, v21
    v_cvt_pk_bf16_f32 v49, v18, v19
    v_exp_f32 v22, v22
    v_exp_f32 v23, v23
    v_cvt_pk_bf16_f32 v50, v20, v21
    v_exp_f32 v24, v24
    v_exp_f32 v25, v25
    v_cvt_pk_bf16_f32 v51, v22, v23
    v_exp_f32 v26, v26
    v_exp_f32 v27, v27
    v_mfma_f32_32x32x16_bf16 v[64:79], v[136:139], v[48:51], v[64:79]
    v_cvt_pk_bf16_f32 v52, v24, v25
    v_exp_f32 v28, v28
    v_exp_f32 v29, v29
    v_cvt_pk_bf16_f32 v53, v26, v27
    v_exp_f32 v30, v30
    v_exp_f32 v31, v31
    v_cvt_pk_bf16_f32 v54, v28, v29
    s_nop 0
    v_cvt_pk_bf16_f32 v55, v30, v31
    s_nop 1
    v_mfma_f32_32x32x16_bf16 v[64:79], v[140:143], v[52:55], v[64:79]
    s_waitcnt lgkmcnt(0)
    s_mov_b64 exec, s[48:49]
    ds_read_b128 v[128:131], v10 offset:10240
    ds_read_b128 v[132:135], v10 offset:10880
    s_mov_b64 exec, -1
    v_mfma_f32_32x32x16_bf16 v[16:31], v[112:115], v[96:99], 0
    v_exp_f32 v32, v32
    v_exp_f32 v33, v33
    v_exp_f32 v34, v34
    v_exp_f32 v35, v35
    v_cvt_pk_bf16_f32 v56, v32, v33
    v_mfma_f32_32x32x8bf16_1k v[16:31], v[116:117], v[100:101], v[16:31]
    v_exp_f32 v36, v36
    v_exp_f32 v37, v37
    v_cvt_pk_bf16_f32 v57, v34, v35
    v_exp_f32 v38, v38
    v_exp_f32 v39, v39
    v_cvt_pk_bf16_f32 v58, v36, v37
    v_exp_f32 v40, v40
    v_exp_f32 v41, v41
    v_cvt_pk_bf16_f32 v59, v38, v39
    v_exp_f32 v42, v42
    v_exp_f32 v43, v43
    v_mfma_f32_32x32x16_bf16 v[80:95], v[136:139], v[56:59], v[80:95]
    v_cvt_pk_bf16_f32 v60, v40, v41
    v_exp_f32 v44, v44
    v_exp_f32 v45, v45
    v_cvt_pk_bf16_f32 v61, v42, v43
    v_exp_f32 v46, v46
    v_exp_f32 v47, v47
    v_cvt_pk_bf16_f32 v62, v44, v45
    s_nop 0
    v_cvt_pk_bf16_f32 v63, v46, v47
    s_nop 1
    v_mfma_f32_32x32x16_bf16 v[80:95], v[140:143], v[60:63], v[80:95]
    v_add_u32 v8, 10240, v8
    v_add_u32 v9, 10240, v9
    v_add_u32 v10, 10240, v10
    s_add_u32 s53, s53, 1
    s_cmp_lt_u32 s53, 4
    s_cbranch_scc1 K2_CHUNK
    s_waitcnt lgkmcnt(0)
    s_nop 15
    s_cmp_lg_u32 s52, 0
    s_cbranch_scc1 K2_COMBINE
    s_mov_b32 s54, 813694976
    s_mov_b32 s55, 1820327936
    v_cmp_le_f32 s[56:57], s54, v76
    v_cmp_ge_f32 s[58:59], s55, v76
    s_and_b64 s[56:57], s[56:57], s[58:59]
    v_cmp_le_f32 s[58:59], s54, v92
    s_and_b64 s[56:57], s[56:57], s[58:59]
    v_cmp_ge_f32 s[58:59], s55, v92
    s_and_b64 s[56:57], s[56:57], s[58:59]
    s_cmp_eq_u64 s[56:57], -1
    s_cbranch_scc1 K2_COMBINE
    s_mov_b32 s52, 1
    v_mov_b32 v102, 0
    v_mov_b32 v103, 0
    v_mov_b32 v110, 0
    v_mov_b32 v111, 0
    s_mov_b64 exec, s[50:51]
    s_not_b64 exec, exec
    v_mov_b32 v100, 0
    v_mov_b32 v101, 0
    v_mov_b32 v108, 0
    v_mov_b32 v109, 0
    s_mov_b64 exec, -1
    v_mov_b32 v8, v14
    v_mov_b32 v9, v15
    v_mov_b32 v144, 0xff800000
    v_mov_b32 v145, 0xff800000
    s_mov_b32 s53, 0
K2_MAXLOOP:
    ds_read_b128 v[112:115], v8 offset:0
    s_mov_b64 exec, s[50:51]
    ds_read_b64 v[116:117], v9 offset:0
    s_mov_b64 exec, -1
    s_waitcnt lgkmcnt(0)
    v_mfma_f32_32x32x16_bf16 v[16:31], v[112:115], v[96:99], 0
    v_mfma_f32_32x32x8bf16_1k v[16:31], v[116:117], v[100:101], v[16:31]
    v_mfma_f32_32x32x16_bf16 v[32:47], v[112:115], v[104:107], 0
    v_mfma_f32_32x32x8bf16_1k v[32:47], v[116:117], v[108:109], v[32:47]
    s_nop 15
    v_max3_f32 v144, v144, v16, v17
    v_max3_f32 v144, v144, v18, v19
    v_max3_f32 v144, v144, v20, v21
    v_max3_f32 v144, v144, v22, v23
    v_max3_f32 v144, v144, v24, v25
    v_max3_f32 v144, v144, v26, v27
    v_max3_f32 v144, v144, v28, v29
    v_max3_f32 v144, v144, v30, v31
    v_max3_f32 v145, v145, v32, v33
    v_max3_f32 v145, v145, v34, v35
    v_max3_f32 v145, v145, v36, v37
    v_max3_f32 v145, v145, v38, v39
    v_max3_f32 v145, v145, v40, v41
    v_max3_f32 v145, v145, v42, v43
    v_max3_f32 v145, v145, v44, v45
    v_max3_f32 v145, v145, v46, v47
    v_add_u32 v8, 1280, v8
    v_add_u32 v9, 1280, v9
    s_add_u32 s53, s53, 1
    s_cmp_lt_u32 s53, 32
    s_cbranch_scc1 K2_MAXLOOP
    s_branch K2_SETM
K2_COMBINE:
    s_barrier
    s_lshl_b32 s43, s39, 13
    v_add_u32 v6, s43, v4
    s_cmp_eq_u32 s40, 0
    s_cbranch_scc1 K2_RECV
    v_mov_b32 v77, v12
    ds_write_b128 v6, v[64:67] offset:0
    ds_write_b128 v6, v[68:71] offset:1024
    ds_write_b128 v6, v[72:75] offset:2048
    ds_write_b128 v6, v[76:79] offset:3072
    v_mov_b32 v93, v13
    ds_write_b128 v6, v[80:83] offset:4096
    ds_write_b128 v6, v[84:87] offset:5120
    ds_write_b128 v6, v[88:91] offset:6144
    ds_write_b128 v6, v[92:95] offset:7168
    s_waitcnt lgkmcnt(0)
    s_barrier
    s_branch K2_FIN
K2_RECV:
    s_barrier
    ds_read_b128 v[16:19], v6 offset:0
    ds_read_b128 v[20:23], v6 offset:1024
    ds_read_b128 v[24:27], v6 offset:2048
    ds_read_b128 v[28:31], v6 offset:3072
    ds_read_b128 v[32:35], v6 offset:4096
    ds_read_b128 v[36:39], v6 offset:5120
    ds_read_b128 v[40:43], v6 offset:6144
    ds_read_b128 v[44:47], v6 offset:7168
    s_lshl_b32 s42, s37, 3
    s_lshl_b32 s43, s39, 1
    s_add_u32 s42, s42, s43
    s_mul_i32 s42, s42, 40960
    s_add_u32 s42, s42, 29360128
    s_lshr_b32 s43, s36, 2
    s_add_u32 s43, s43, 32
    s_lshl_b32 s43, s43, 10
    s_lshr_b32 s44, s36, 1
    s_and_b32 s44, s44, 1
    s_lshl_b32 s44, s44, 9
    s_add_u32 s43, s43, s44
    s_and_b32 s44, s36, 1
    s_lshl_b32 s44, s44, 3
    s_add_u32 s43, s43, s44
    s_add_u32 s43, s43, s42
    s_lshl_b32 s44, s36, 10
    s_add_u32 s42, s42, s44
    v_lshlrev_b32 v7, 4, v2
    s_waitcnt lgkmcnt(0)
    v_max_f32 v144, v12, v29
    v_sub_f32 v145, v12, v144
    v_sub_f32 v146, v29, v144
    v_exp_f32 v145, v145
    v_exp_f32 v146, v146
    s_nop 0
    v_mul_f32 v147, v76, v145
    v_fma_f32 v147, v28, v146, v147
    v_rcp_f32 v147, v147
    s_nop 0
    v_mul_f32 v145, v145, v147
    v_mul_f32 v146, v146, v147
    v_mul_f32 v64, v64, v145
    v_fma_f32 v64, v16, v146, v64
    v_mul_f32 v65, v65, v145
    v_fma_f32 v65, v17, v146, v65
    v_mul_f32 v66, v66, v145
    v_fma_f32 v66, v18, v146, v66
    v_mul_f32 v67, v67, v145
    v_fma_f32 v67, v19, v146, v67
    v_mul_f32 v68, v68, v145
    v_fma_f32 v68, v20, v146, v68
    v_mul_f32 v69, v69, v145
    v_fma_f32 v69, v21, v146, v69
    v_mul_f32 v70, v70, v145
    v_fma_f32 v70, v22, v146, v70
    v_mul_f32 v71, v71, v145
    v_fma_f32 v71, v23, v146, v71
    v_mul_f32 v72, v72, v145
    v_fma_f32 v72, v24, v146, v72
    v_mul_f32 v73, v73, v145
    v_fma_f32 v73, v25, v146, v73
    v_mul_f32 v74, v74, v145
    v_fma_f32 v74, v26, v146, v74
    v_mul_f32 v75, v75, v145
    v_fma_f32 v75, v27, v146, v75
    v_cvt_pk_bf16_f32 v148, v64, v65
    v_cvt_pk_bf16_f32 v149, v66, v67
    v_cvt_pk_bf16_f32 v150, v68, v69
    v_cvt_pk_bf16_f32 v151, v70, v71
    v_cvt_pk_bf16_f32 v152, v72, v73
    v_cvt_pk_bf16_f32 v153, v74, v75
    buffer_store_dwordx4 v[148:151], v4, s[16:19], s42 offen sc0 sc1
    s_mov_b64 exec, s[50:51]
    buffer_store_dwordx2 v[152:153], v7, s[16:19], s43 offen sc0 sc1
    s_mov_b64 exec, -1
    s_add_u32 s42, s42, 40960
    s_add_u32 s43, s43, 40960
    v_max_f32 v144, v13, v45
    v_sub_f32 v145, v13, v144
    v_sub_f32 v146, v45, v144
    v_exp_f32 v145, v145
    v_exp_f32 v146, v146
    s_nop 0
    v_mul_f32 v147, v92, v145
    v_fma_f32 v147, v44, v146, v147
    v_rcp_f32 v147, v147
    s_nop 0
    v_mul_f32 v145, v145, v147
    v_mul_f32 v146, v146, v147
    v_mul_f32 v80, v80, v145
    v_fma_f32 v80, v32, v146, v80
    v_mul_f32 v81, v81, v145
    v_fma_f32 v81, v33, v146, v81
    v_mul_f32 v82, v82, v145
    v_fma_f32 v82, v34, v146, v82
    v_mul_f32 v83, v83, v145
    v_fma_f32 v83, v35, v146, v83
    v_mul_f32 v84, v84, v145
    v_fma_f32 v84, v36, v146, v84
    v_mul_f32 v85, v85, v145
    v_fma_f32 v85, v37, v146, v85
    v_mul_f32 v86, v86, v145
    v_fma_f32 v86, v38, v146, v86
    v_mul_f32 v87, v87, v145
    v_fma_f32 v87, v39, v146, v87
    v_mul_f32 v88, v88, v145
    v_fma_f32 v88, v40, v146, v88
    v_mul_f32 v89, v89, v145
    v_fma_f32 v89, v41, v146, v89
    v_mul_f32 v90, v90, v145
    v_fma_f32 v90, v42, v146, v90
    v_mul_f32 v91, v91, v145
    v_fma_f32 v91, v43, v146, v91
    v_cvt_pk_bf16_f32 v148, v80, v81
    v_cvt_pk_bf16_f32 v149, v82, v83
    v_cvt_pk_bf16_f32 v150, v84, v85
    v_cvt_pk_bf16_f32 v151, v86, v87
    v_cvt_pk_bf16_f32 v152, v88, v89
    v_cvt_pk_bf16_f32 v153, v90, v91
    buffer_store_dwordx4 v[148:151], v4, s[16:19], s42 offen sc0 sc1
    s_mov_b64 exec, s[50:51]
    buffer_store_dwordx2 v[152:153], v7, s[16:19], s43 offen sc0 sc1
    s_mov_b64 exec, -1
    s_add_u32 s42, s42, 40960
    s_add_u32 s43, s43, 40960
    s_branch K2_FIN
K2_MLP:
    s_mov_b32 s54, s41
    s_sub_u32 s38, s38, 8
    s_and_b32 s3, s2, 7
    s_lshr_b32 s36, s2, 3
    s_lshl_b32 s3, s3, 3
    s_lshr_b32 s37, s36, 2
    s_add_u32 s37, s37, s3
    s_and_b32 s36, s36, 3
    s_mul_i32 s39, s38, 27
    s_mul_i32 s46, s36, 540
    s_add_u32 s46, s46, s39
    s_lshl_b32 s46, s46, 10
    s_add_u32 s40, s46, 20971520
    s_add_u32 s41, s40, 110592
    s_add_u32 s42, s41, 110592
    s_add_u32 s43, s42, 110592
    s_add_u32 s44, s43, 110592
    s_mul_i32 s45, s37, 108
    s_add_u32 s45, s45, s39
    s_lshl_b32 s45, s45, 10
    s_add_u32 s45, s45, 12582912
    s_and_b32 s50, s38, 1
    s_mul_i32 s50, s50, 40960
    s_lshr_b32 s51, s38, 1
    s_mul_i32 s52, s51, 81920
    s_add_u32 s52, s52, s50
    s_cmp_eq_u32 s51, 1
    s_mov_b32 s53, 4194304
    s_cselect_b32 s53, 8388608, s53
    s_add_u32 s53, s53, s54
    s_add_u32 s53, s53, s50
    s_barrier
    s_add_u32 m0, s52, 10240
    s_add_u32 s50, s53, 10240
    buffer_load_dwordx4 v4, s[16:19], s50 offen offset:0 lds
    buffer_load_dwordx4 v4, s[16:19], s50 offen offset:1024 lds
    buffer_load_dwordx4 v4, s[16:19], s50 offen offset:2048 lds
    buffer_load_dwordx4 v4, s[16:19], s50 offen offset:3072 lds
    s_add_u32 m0, s52, 14336
    s_add_u32 s50, s53, 14336
    buffer_load_dwordx4 v4, s[16:19], s50 offen offset:0 lds
    buffer_load_dwordx4 v4, s[16:19], s50 offen offset:1024 lds
    buffer_load_dwordx4 v4, s[16:19], s50 offen offset:2048 lds
    buffer_load_dwordx4 v4, s[16:19], s50 offen offset:3072 lds
    s_add_u32 m0, s52, 18432
    s_add_u32 s50, s53, 18432
    buffer_load_dwordx4 v4, s[16:19], s50 offen offset:0 lds
    buffer_load_dwordx4 v4, s[16:19], s50 offen offset:1024 lds
    buffer_load_dwordx4 v4, s[16:19], s50 offen offset:2048 lds
    buffer_load_dwordx4 v4, s[16:19], s50 offen offset:3072 lds
    s_add_u32 m0, s52, 22528
    s_add_u32 s50, s53, 22528
    buffer_load_dwordx4 v4, s[16:19], s50 offen offset:0 lds
    buffer_load_dwordx4 v4, s[16:19], s50 offen offset:1024 lds
    buffer_load_dwordx4 v4, s[16:19], s50 offen offset:2048 lds
    buffer_load_dwordx4 v4, s[16:19], s50 offen offset:3072 lds
    s_add_u32 m0, s52, 26624
    s_add_u32 s50, s53, 26624
    buffer_load_dwordx4 v4, s[16:19], s50 offen offset:0 lds
    buffer_load_dwordx4 v4, s[16:19], s50 offen offset:1024 lds
    buffer_load_dwordx4 v4, s[16:19], s50 offen offset:2048 lds
    buffer_load_dwordx4 v4, s[16:19], s50 offen offset:3072 lds
    s_add_u32 m0, s52, 30720
    s_add_u32 s50, s53, 30720
    buffer_load_dwordx4 v4, s[16:19], s50 offen offset:0 lds
    buffer_load_dwordx4 v4, s[16:19], s50 offen offset:1024 lds
    buffer_load_dwordx4 v4, s[16:19], s50 offen offset:2048 lds
    buffer_load_dwordx4 v4, s[16:19], s50 offen offset:3072 lds
    s_add_u32 m0, s52, 34816
    s_add_u32 s50, s53, 34816
    buffer_load_dwordx4 v4, s[16:19], s50 offen offset:0 lds
    buffer_load_dwordx4 v4, s[16:19], s50 offen offset:1024 lds
    buffer_load_dwordx4 v4, s[16:19], s50 offen offset:2048 lds
    buffer_load_dwordx4 v4, s[16:19], s50 offen offset:3072 lds
    s_add_u32 m0, s52, 38912
    s_add_u32 s50, s53, 38912
    buffer_load_dwordx4 v4, s[16:19], s50 offen offset:0 lds
    buffer_load_dwordx4 v4, s[16:19], s50 offen offset:1024 lds
    buffer_load_dwordx4 v[96:99], v4, s[16:19], s45 offen offset:0
    buffer_load_dwordx4 v[100:103], v4, s[16:19], s40 offen offset:0
    buffer_load_dwordx4 v[104:107], v4, s[16:19], s41 offen offset:0
    buffer_load_dwordx4 v[108:111], v4, s[16:19], s42 offen offset:0
    buffer_load_dwordx4 v[112:115], v4, s[16:19], s43 offen offset:0
    buffer_load_dwordx4 v[116:119], v4, s[16:19], s44 offen offset:0
    buffer_load_dwordx4 v[120:123], v4, s[16:19], s45 offen offset:1024
    buffer_load_dwordx4 v[124:127], v4, s[16:19], s40 offen offset:1024
    buffer_load_dwordx4 v[128:131], v4, s[16:19], s41 offen offset:1024
    buffer_load_dwordx4 v[132:135], v4, s[16:19], s42 offen offset:1024
    buffer_load_dwordx4 v[136:139], v4, s[16:19], s43 offen offset:1024
    buffer_load_dwordx4 v[140:143], v4, s[16:19], s44 offen offset:1024
    buffer_load_dwordx4 v[144:147], v4, s[16:19], s45 offen offset:2048
    buffer_load_dwordx4 v[148:151], v4, s[16:19], s40 offen offset:2048
    buffer_load_dwordx4 v[152:155], v4, s[16:19], s41 offen offset:2048
    buffer_load_dwordx4 v[156:159], v4, s[16:19], s42 offen offset:2048
    buffer_load_dwordx4 v[160:163], v4, s[16:19], s43 offen offset:2048
    buffer_load_dwordx4 v[164:167], v4, s[16:19], s44 offen offset:2048
    s_waitcnt vmcnt(12)
    v_mfma_f32_32x32x16_bf16 v[16:31], v[100:103], v[96:99], 0
    v_mfma_f32_32x32x16_bf16 v[32:47], v[104:107], v[96:99], 0
    v_mfma_f32_32x32x16_bf16 v[48:63], v[108:111], v[96:99], 0
    v_mfma_f32_32x32x16_bf16 v[64:79], v[112:115], v[96:99], 0
    v_mfma_f32_32x32x16_bf16 v[80:95], v[116:119], v[96:99], 0
    buffer_load_dwordx4 v[96:99], v4, s[16:19], s45 offen offset:3072
    buffer_load_dwordx4 v[100:103], v4, s[16:19], s40 offen offset:3072
    buffer_load_dwordx4 v[104:107], v4, s[16:19], s41 offen offset:3072
    buffer_load_dwordx4 v[108:111], v4, s[16:19], s42 offen offset:3072
    buffer_load_dwordx4 v[112:115], v4, s[16:19], s43 offen offset:3072
    buffer_load_dwordx4 v[116:119], v4, s[16:19], s44 offen offset:3072
    s_add_u32 s40, s40, 4096
    s_add_u32 s41, s41, 4096
    s_add_u32 s42, s42, 4096
    s_add_u32 s43, s43, 4096
    s_add_u32 s44, s44, 4096
    s_add_u32 s45, s45, 4096
    s_waitcnt vmcnt(12)
    v_mfma_f32_32x32x16_bf16 v[16:31], v[124:127], v[120:123], v[16:31]
    v_mfma_f32_32x32x16_bf16 v[32:47], v[128:131], v[120:123], v[32:47]
    v_mfma_f32_32x32x16_bf16 v[48:63], v[132:135], v[120:123], v[48:63]
    v_mfma_f32_32x32x16_bf16 v[64:79], v[136:139], v[120:123], v[64:79]
    v_mfma_f32_32x32x16_bf16 v[80:95], v[140:143], v[120:123], v[80:95]
    buffer_load_dwordx4 v[120:123], v4, s[16:19], s45 offen offset:0
    buffer_load_dwordx4 v[124:127], v4, s[16:19], s40 offen offset:0
    buffer_load_dwordx4 v[128:131], v4, s[16:19], s41 offen offset:0
    buffer_load_dwordx4 v[132:135], v4, s[16:19], s42 offen offset:0
    buffer_load_dwordx4 v[136:139], v4, s[16:19], s43 offen offset:0
    buffer_load_dwordx4 v[140:143], v4, s[16:19], s44 offen offset:0
    s_waitcnt vmcnt(12)
    v_mfma_f32_32x32x16_bf16 v[16:31], v[148:151], v[144:147], v[16:31]
    v_mfma_f32_32x32x16_bf16 v[32:47], v[152:155], v[144:147], v[32:47]
    v_mfma_f32_32x32x16_bf16 v[48:63], v[156:159], v[144:147], v[48:63]
    v_mfma_f32_32x32x16_bf16 v[64:79], v[160:163], v[144:147], v[64:79]
    v_mfma_f32_32x32x16_bf16 v[80:95], v[164:167], v[144:147], v[80:95]
    buffer_load_dwordx4 v[144:147], v4, s[16:19], s45 offen offset:1024
    buffer_load_dwordx4 v[148:151], v4, s[16:19], s40 offen offset:1024
    buffer_load_dwordx4 v[152:155], v4, s[16:19], s41 offen offset:1024
    buffer_load_dwordx4 v[156:159], v4, s[16:19], s42 offen offset:1024
    buffer_load_dwordx4 v[160:163], v4, s[16:19], s43 offen offset:1024
    buffer_load_dwordx4 v[164:167], v4, s[16:19], s44 offen offset:1024
    s_waitcnt vmcnt(12)
    v_mfma_f32_32x32x16_bf16 v[16:31], v[100:103], v[96:99], v[16:31]
    v_mfma_f32_32x32x16_bf16 v[32:47], v[104:107], v[96:99], v[32:47]
    v_mfma_f32_32x32x16_bf16 v[48:63], v[108:111], v[96:99], v[48:63]
    v_mfma_f32_32x32x16_bf16 v[64:79], v[112:115], v[96:99], v[64:79]
    v_mfma_f32_32x32x16_bf16 v[80:95], v[116:119], v[96:99], v[80:95]
    buffer_load_dwordx4 v[96:99], v4, s[16:19], s45 offen offset:2048
    buffer_load_dwordx4 v[100:103], v4, s[16:19], s40 offen offset:2048
    buffer_load_dwordx4 v[104:107], v4, s[16:19], s41 offen offset:2048
    buffer_load_dwordx4 v[108:111], v4, s[16:19], s42 offen offset:2048
    buffer_load_dwordx4 v[112:115], v4, s[16:19], s43 offen offset:2048
    buffer_load_dwordx4 v[116:119], v4, s[16:19], s44 offen offset:2048
    s_waitcnt vmcnt(12)
    v_mfma_f32_32x32x16_bf16 v[16:31], v[124:127], v[120:123], v[16:31]
    v_mfma_f32_32x32x16_bf16 v[32:47], v[128:131], v[120:123], v[32:47]
    v_mfma_f32_32x32x16_bf16 v[48:63], v[132:135], v[120:123], v[48:63]
    v_mfma_f32_32x32x16_bf16 v[64:79], v[136:139], v[120:123], v[64:79]
    v_mfma_f32_32x32x16_bf16 v[80:95], v[140:143], v[120:123], v[80:95]
    buffer_load_dwordx4 v[120:123], v4, s[16:19], s45 offen offset:3072
    buffer_load_dwordx4 v[124:127], v4, s[16:19], s40 offen offset:3072
    buffer_load_dwordx4 v[128:131], v4, s[16:19], s41 offen offset:3072
    buffer_load_dwordx4 v[132:135], v4, s[16:19], s42 offen offset:3072
    buffer_load_dwordx4 v[136:139], v4, s[16:19], s43 offen offset:3072
    buffer_load_dwordx4 v[140:143], v4, s[16:19], s44 offen offset:3072
    s_add_u32 s40, s40, 4096
    s_add_u32 s41, s41, 4096
    s_add_u32 s42, s42, 4096
    s_add_u32 s43, s43, 4096
    s_add_u32 s44, s44, 4096
    s_add_u32 s45, s45, 4096
    s_waitcnt vmcnt(12)
    v_mfma_f32_32x32x16_bf16 v[16:31], v[148:151], v[144:147], v[16:31]
    v_mfma_f32_32x32x16_bf16 v[32:47], v[152:155], v[144:147], v[32:47]
    v_mfma_f32_32x32x16_bf16 v[48:63], v[156:159], v[144:147], v[48:63]
    v_mfma_f32_32x32x16_bf16 v[64:79], v[160:163], v[144:147], v[64:79]
    v_mfma_f32_32x32x16_bf16 v[80:95], v[164:167], v[144:147], v[80:95]
    buffer_load_dwordx4 v[144:147], v4, s[16:19], s45 offen offset:0
    buffer_load_dwordx4 v[148:151], v4, s[16:19], s40 offen offset:0
    buffer_load_dwordx4 v[152:155], v4, s[16:19], s41 offen offset:0
    buffer_load_dwordx4 v[156:159], v4, s[16:19], s42 offen offset:0
    buffer_load_dwordx4 v[160:163], v4, s[16:19], s43 offen offset:0
    buffer_load_dwordx4 v[164:167], v4, s[16:19], s44 offen offset:0
    s_barrier
    s_waitcnt vmcnt(12)
    v_mfma_f32_32x32x16_bf16 v[16:31], v[100:103], v[96:99], v[16:31]
    v_mfma_f32_32x32x16_bf16 v[32:47], v[104:107], v[96:99], v[32:47]
    v_mfma_f32_32x32x16_bf16 v[48:63], v[108:111], v[96:99], v[48:63]
    v_mfma_f32_32x32x16_bf16 v[64:79], v[112:115], v[96:99], v[64:79]
    v_mfma_f32_32x32x16_bf16 v[80:95], v[116:119], v[96:99], v[80:95]
    buffer_load_dwordx4 v[96:99], v4, s[16:19], s45 offen offset:1024
    buffer_load_dwordx4 v[100:103], v4, s[16:19], s40 offen offset:1024
    buffer_load_dwordx4 v[104:107], v4, s[16:19], s41 offen offset:1024
    buffer_load_dwordx4 v[108:111], v4, s[16:19], s42 offen offset:1024
    buffer_load_dwordx4 v[112:115], v4, s[16:19], s43 offen offset:1024
    buffer_load_dwordx4 v[116:119], v4, s[16:19], s44 offen offset:1024
    s_waitcnt vmcnt(12)
    v_mfma_f32_32x32x16_bf16 v[16:31], v[124:127], v[120:123], v[16:31]
    v_mfma_f32_32x32x16_bf16 v[32:47], v[128:131], v[120:123], v[32:47]
    v_mfma_f32_32x32x16_bf16 v[48:63], v[132:135], v[120:123], v[48:63]
    v_mfma_f32_32x32x16_bf16 v[64:79], v[136:139], v[120:123], v[64:79]
    v_mfma_f32_32x32x16_bf16 v[80:95], v[140:143], v[120:123], v[80:95]
    buffer_load_dwordx4 v[120:123], v4, s[16:19], s45 offen offset:2048
    buffer_load_dwordx4 v[124:127], v4, s[16:19], s40 offen offset:2048
    buffer_load_dwordx4 v[128:131], v4, s[16:19], s41 offen offset:2048
    buffer_load_dwordx4 v[132:135], v4, s[16:19], s42 offen offset:2048
    buffer_load_dwordx4 v[136:139], v4, s[16:19], s43 offen offset:2048
    buffer_load_dwordx4 v[140:143], v4, s[16:19], s44 offen offset:2048
    s_waitcnt vmcnt(12)
    v_mfma_f32_32x32x16_bf16 v[16:31], v[148:151], v[144:147], v[16:31]
    v_mfma_f32_32x32x16_bf16 v[32:47], v[152:155], v[144:147], v[32:47]
    v_mfma_f32_32x32x16_bf16 v[48:63], v[156:159], v[144:147], v[48:63]
    v_mfma_f32_32x32x16_bf16 v[64:79], v[160:163], v[144:147], v[64:79]
    v_mfma_f32_32x32x16_bf16 v[80:95], v[164:167], v[144:147], v[80:95]
    buffer_load_dwordx4 v[144:147], v4, s[16:19], s45 offen offset:3072
    buffer_load_dwordx4 v[148:151], v4, s[16:19], s40 offen offset:3072
    buffer_load_dwordx4 v[152:155], v4, s[16:19], s41 offen offset:3072
    buffer_load_dwordx4 v[156:159], v4, s[16:19], s42 offen offset:3072
    buffer_load_dwordx4 v[160:163], v4, s[16:19], s43 offen offset:3072
    buffer_load_dwordx4 v[164:167], v4, s[16:19], s44 offen offset:3072
    s_add_u32 s40, s40, 4096
    s_add_u32 s41, s41, 4096
    s_add_u32 s42, s42, 4096
    s_add_u32 s43, s43, 4096
    s_add_u32 s44, s44, 4096
    s_add_u32 s45, s45, 4096
    s_waitcnt vmcnt(12)
    v_mfma_f32_32x32x16_bf16 v[16:31], v[100:103], v[96:99], v[16:31]
    v_mfma_f32_32x32x16_bf16 v[32:47], v[104:107], v[96:99], v[32:47]
    v_mfma_f32_32x32x16_bf16 v[48:63], v[108:111], v[96:99], v[48:63]
    v_mfma_f32_32x32x16_bf16 v[64:79], v[112:115], v[96:99], v[64:79]
    v_mfma_f32_32x32x16_bf16 v[80:95], v[116:119], v[96:99], v[80:95]
    buffer_load_dwordx4 v[96:99], v4, s[16:19], s45 offen offset:0
    buffer_load_dwordx4 v[100:103], v4, s[16:19], s40 offen offset:0
    buffer_load_dwordx4 v[104:107], v4, s[16:19], s41 offen offset:0
    buffer_load_dwordx4 v[108:111], v4, s[16:19], s42 offen offset:0
    buffer_load_dwordx4 v[112:115], v4, s[16:19], s43 offen offset:0
    buffer_load_dwordx4 v[116:119], v4, s[16:19], s44 offen offset:0
    s_waitcnt vmcnt(12)
    v_mfma_f32_32x32x16_bf16 v[16:31], v[124:127], v[120:123], v[16:31]
    v_mfma_f32_32x32x16_bf16 v[32:47], v[128:131], v[120:123], v[32:47]
    v_mfma_f32_32x32x16_bf16 v[48:63], v[132:135], v[120:123], v[48:63]
    v_mfma_f32_32x32x16_bf16 v[64:79], v[136:139], v[120:123], v[64:79]
    v_mfma_f32_32x32x16_bf16 v[80:95], v[140:143], v[120:123], v[80:95]
    buffer_load_dwordx4 v[120:123], v4, s[16:19], s45 offen offset:1024
    buffer_load_dwordx4 v[124:127], v4, s[16:19], s40 offen offset:1024
    buffer_load_dwordx4 v[128:131], v4, s[16:19], s41 offen offset:1024
    buffer_load_dwordx4 v[132:135], v4, s[16:19], s42 offen offset:1024
    buffer_load_dwordx4 v[136:139], v4, s[16:19], s43 offen offset:1024
    buffer_load_dwordx4 v[140:143], v4, s[16:19], s44 offen offset:1024
    s_waitcnt vmcnt(12)
    v_mfma_f32_32x32x16_bf16 v[16:31], v[148:151], v[144:147], v[16:31]
    v_mfma_f32_32x32x16_bf16 v[32:47], v[152:155], v[144:147], v[32:47]
    v_mfma_f32_32x32x16_bf16 v[48:63], v[156:159], v[144:147], v[48:63]
    v_mfma_f32_32x32x16_bf16 v[64:79], v[160:163], v[144:147], v[64:79]
    v_mfma_f32_32x32x16_bf16 v[80:95], v[164:167], v[144:147], v[80:95]
    buffer_load_dwordx4 v[144:147], v4, s[16:19], s45 offen offset:2048
    buffer_load_dwordx4 v[148:151], v4, s[16:19], s40 offen offset:2048
    buffer_load_dwordx4 v[152:155], v4, s[16:19], s41 offen offset:2048
    buffer_load_dwordx4 v[156:159], v4, s[16:19], s42 offen offset:2048
    buffer_load_dwordx4 v[160:163], v4, s[16:19], s43 offen offset:2048
    buffer_load_dwordx4 v[164:167], v4, s[16:19], s44 offen offset:2048
    s_waitcnt vmcnt(12)
    v_mfma_f32_32x32x16_bf16 v[16:31], v[100:103], v[96:99], v[16:31]
    v_mfma_f32_32x32x16_bf16 v[32:47], v[104:107], v[96:99], v[32:47]
    v_mfma_f32_32x32x16_bf16 v[48:63], v[108:111], v[96:99], v[48:63]
    v_mfma_f32_32x32x16_bf16 v[64:79], v[112:115], v[96:99], v[64:79]
    v_mfma_f32_32x32x16_bf16 v[80:95], v[116:119], v[96:99], v[80:95]
    buffer_load_dwordx4 v[96:99], v4, s[16:19], s45 offen offset:3072
    buffer_load_dwordx4 v[100:103], v4, s[16:19], s40 offen offset:3072
    buffer_load_dwordx4 v[104:107], v4, s[16:19], s41 offen offset:3072
    buffer_load_dwordx4 v[108:111], v4, s[16:19], s42 offen offset:3072
    buffer_load_dwordx4 v[112:115], v4, s[16:19], s43 offen offset:3072
    buffer_load_dwordx4 v[116:119], v4, s[16:19], s44 offen offset:3072
    s_add_u32 s40, s40, 4096
    s_add_u32 s41, s41, 4096
    s_add_u32 s42, s42, 4096
    s_add_u32 s43, s43, 4096
    s_add_u32 s44, s44, 4096
    s_add_u32 s45, s45, 4096
    s_waitcnt vmcnt(12)
    v_mfma_f32_32x32x16_bf16 v[16:31], v[124:127], v[120:123], v[16:31]
    v_mfma_f32_32x32x16_bf16 v[32:47], v[128:131], v[120:123], v[32:47]
    v_mfma_f32_32x32x16_bf16 v[48:63], v[132:135], v[120:123], v[48:63]
    v_mfma_f32_32x32x16_bf16 v[64:79], v[136:139], v[120:123], v[64:79]
    v_mfma_f32_32x32x16_bf16 v[80:95], v[140:143], v[120:123], v[80:95]
    buffer_load_dwordx4 v[120:123], v4, s[16:19], s45 offen offset:0
    buffer_load_dwordx4 v[124:127], v4, s[16:19], s40 offen offset:0
    buffer_load_dwordx4 v[128:131], v4, s[16:19], s41 offen offset:0
    buffer_load_dwordx4 v[132:135], v4, s[16:19], s42 offen offset:0
    buffer_load_dwordx4 v[136:139], v4, s[16:19], s43 offen offset:0
    buffer_load_dwordx4 v[140:143], v4, s[16:19], s44 offen offset:0
    s_waitcnt vmcnt(12)
    v_mfma_f32_32x32x16_bf16 v[16:31], v[148:151], v[144:147], v[16:31]
    v_mfma_f32_32x32x16_bf16 v[32:47], v[152:155], v[144:147], v[32:47]
    v_mfma_f32_32x32x16_bf16 v[48:63], v[156:159], v[144:147], v[48:63]
    v_mfma_f32_32x32x16_bf16 v[64:79], v[160:163], v[144:147], v[64:79]
    v_mfma_f32_32x32x16_bf16 v[80:95], v[164:167], v[144:147], v[80:95]
    buffer_load_dwordx4 v[144:147], v4, s[16:19], s45 offen offset:1024
    buffer_load_dwordx4 v[148:151], v4, s[16:19], s40 offen offset:1024
    buffer_load_dwordx4 v[152:155], v4, s[16:19], s41 offen offset:1024
    buffer_load_dwordx4 v[156:159], v4, s[16:19], s42 offen offset:1024
    buffer_load_dwordx4 v[160:163], v4, s[16:19], s43 offen offset:1024
    buffer_load_dwordx4 v[164:167], v4, s[16:19], s44 offen offset:1024
    s_waitcnt vmcnt(12)
    v_mfma_f32_32x32x16_bf16 v[16:31], v[100:103], v[96:99], v[16:31]
    v_mfma_f32_32x32x16_bf16 v[32:47], v[104:107], v[96:99], v[32:47]
    v_mfma_f32_32x32x16_bf16 v[48:63], v[108:111], v[96:99], v[48:63]
    v_mfma_f32_32x32x16_bf16 v[64:79], v[112:115], v[96:99], v[64:79]
    v_mfma_f32_32x32x16_bf16 v[80:95], v[116:119], v[96:99], v[80:95]
    buffer_load_dwordx4 v[96:99], v4, s[16:19], s45 offen offset:2048
    buffer_load_dwordx4 v[100:103], v4, s[16:19], s40 offen offset:2048
    buffer_load_dwordx4 v[104:107], v4, s[16:19], s41 offen offset:2048
    buffer_load_dwordx4 v[108:111], v4, s[16:19], s42 offen offset:2048
    buffer_load_dwordx4 v[112:115], v4, s[16:19], s43 offen offset:2048
    buffer_load_dwordx4 v[116:119], v4, s[16:19], s44 offen offset:2048
    s_waitcnt vmcnt(12)
    v_mfma_f32_32x32x16_bf16 v[16:31], v[124:127], v[120:123], v[16:31]
    v_mfma_f32_32x32x16_bf16 v[32:47], v[128:131], v[120:123], v[32:47]
    v_mfma_f32_32x32x16_bf16 v[48:63], v[132:135], v[120:123], v[48:63]
    v_mfma_f32_32x32x16_bf16 v[64:79], v[136:139], v[120:123], v[64:79]
    v_mfma_f32_32x32x16_bf16 v[80:95], v[140:143], v[120:123], v[80:95]
    buffer_load_dwordx4 v[120:123], v4, s[16:19], s45 offen offset:3072
    buffer_load_dwordx4 v[124:127], v4, s[16:19], s40 offen offset:3072
    buffer_load_dwordx4 v[128:131], v4, s[16:19], s41 offen offset:3072
    buffer_load_dwordx4 v[132:135], v4, s[16:19], s42 offen offset:3072
    buffer_load_dwordx4 v[136:139], v4, s[16:19], s43 offen offset:3072
    buffer_load_dwordx4 v[140:143], v4, s[16:19], s44 offen offset:3072
    s_add_u32 s40, s40, 4096
    s_add_u32 s41, s41, 4096
    s_add_u32 s42, s42, 4096
    s_add_u32 s43, s43, 4096
    s_add_u32 s44, s44, 4096
    s_add_u32 s45, s45, 4096
    s_waitcnt vmcnt(12)
    v_mfma_f32_32x32x16_bf16 v[16:31], v[148:151], v[144:147], v[16:31]
    v_mfma_f32_32x32x16_bf16 v[32:47], v[152:155], v[144:147], v[32:47]
    v_mfma_f32_32x32x16_bf16 v[48:63], v[156:159], v[144:147], v[48:63]
    v_mfma_f32_32x32x16_bf16 v[64:79], v[160:163], v[144:147], v[64:79]
    v_mfma_f32_32x32x16_bf16 v[80:95], v[164:167], v[144:147], v[80:95]
    buffer_load_dwordx4 v[144:147], v4, s[16:19], s45 offen offset:0
    buffer_load_dwordx4 v[148:151], v4, s[16:19], s40 offen offset:0
    buffer_load_dwordx4 v[152:155], v4, s[16:19], s41 offen offset:0
    buffer_load_dwordx4 v[156:159], v4, s[16:19], s42 offen offset:0
    buffer_load_dwordx4 v[160:163], v4, s[16:19], s43 offen offset:0
    buffer_load_dwordx4 v[164:167], v4, s[16:19], s44 offen offset:0
    s_waitcnt vmcnt(12)
    v_mfma_f32_32x32x16_bf16 v[16:31], v[100:103], v[96:99], v[16:31]
    v_mfma_f32_32x32x16_bf16 v[32:47], v[104:107], v[96:99], v[32:47]
    v_mfma_f32_32x32x16_bf16 v[48:63], v[108:111], v[96:99], v[48:63]
    v_mfma_f32_32x32x16_bf16 v[64:79], v[112:115], v[96:99], v[64:79]
    v_mfma_f32_32x32x16_bf16 v[80:95], v[116:119], v[96:99], v[80:95]
    buffer_load_dwordx4 v[96:99], v4, s[16:19], s45 offen offset:1024
    buffer_load_dwordx4 v[100:103], v4, s[16:19], s40 offen offset:1024
    buffer_load_dwordx4 v[104:107], v4, s[16:19], s41 offen offset:1024
    buffer_load_dwordx4 v[108:111], v4, s[16:19], s42 offen offset:1024
    buffer_load_dwordx4 v[112:115], v4, s[16:19], s43 offen offset:1024
    buffer_load_dwordx4 v[116:119], v4, s[16:19], s44 offen offset:1024
    s_barrier
    s_waitcnt vmcnt(12)
    v_mfma_f32_32x32x16_bf16 v[16:31], v[124:127], v[120:123], v[16:31]
    v_mfma_f32_32x32x16_bf16 v[32:47], v[128:131], v[120:123], v[32:47]
    v_mfma_f32_32x32x16_bf16 v[48:63], v[132:135], v[120:123], v[48:63]
    v_mfma_f32_32x32x16_bf16 v[64:79], v[136:139], v[120:123], v[64:79]
    v_mfma_f32_32x32x16_bf16 v[80:95], v[140:143], v[120:123], v[80:95]
    buffer_load_dwordx4 v[120:123], v4, s[16:19], s45 offen offset:2048
    buffer_load_dwordx4 v[124:127], v4, s[16:19], s40 offen offset:2048
    buffer_load_dwordx4 v[128:131], v4, s[16:19], s41 offen offset:2048
    buffer_load_dwordx4 v[132:135], v4, s[16:19], s42 offen offset:2048
    buffer_load_dwordx4 v[136:139], v4, s[16:19], s43 offen offset:2048
    buffer_load_dwordx4 v[140:143], v4, s[16:19], s44 offen offset:2048
    s_waitcnt vmcnt(12)
    v_mfma_f32_32x32x16_bf16 v[16:31], v[148:151], v[144:147], v[16:31]
    v_mfma_f32_32x32x16_bf16 v[32:47], v[152:155], v[144:147], v[32:47]
    v_mfma_f32_32x32x16_bf16 v[48:63], v[156:159], v[144:147], v[48:63]
    v_mfma_f32_32x32x16_bf16 v[64:79], v[160:163], v[144:147], v[64:79]
    v_mfma_f32_32x32x16_bf16 v[80:95], v[164:167], v[144:147], v[80:95]
    buffer_load_dwordx4 v[144:147], v4, s[16:19], s45 offen offset:3072
    buffer_load_dwordx4 v[148:151], v4, s[16:19], s40 offen offset:3072
    buffer_load_dwordx4 v[152:155], v4, s[16:19], s41 offen offset:3072
    buffer_load_dwordx4 v[156:159], v4, s[16:19], s42 offen offset:3072
    buffer_load_dwordx4 v[160:163], v4, s[16:19], s43 offen offset:3072
    buffer_load_dwordx4 v[164:167], v4, s[16:19], s44 offen offset:3072
    s_add_u32 s40, s40, 4096
    s_add_u32 s41, s41, 4096
    s_add_u32 s42, s42, 4096
    s_add_u32 s43, s43, 4096
    s_add_u32 s44, s44, 4096
    s_add_u32 s45, s45, 4096
    s_waitcnt vmcnt(12)
    v_mfma_f32_32x32x16_bf16 v[16:31], v[100:103], v[96:99], v[16:31]
    v_mfma_f32_32x32x16_bf16 v[32:47], v[104:107], v[96:99], v[32:47]
    v_mfma_f32_32x32x16_bf16 v[48:63], v[108:111], v[96:99], v[48:63]
    v_mfma_f32_32x32x16_bf16 v[64:79], v[112:115], v[96:99], v[64:79]
    v_mfma_f32_32x32x16_bf16 v[80:95], v[116:119], v[96:99], v[80:95]
    buffer_load_dwordx4 v[96:99], v4, s[16:19], s45 offen offset:0
    buffer_load_dwordx4 v[100:103], v4, s[16:19], s40 offen offset:0
    buffer_load_dwordx4 v[104:107], v4, s[16:19], s41 offen offset:0
    buffer_load_dwordx4 v[108:111], v4, s[16:19], s42 offen offset:0
    buffer_load_dwordx4 v[112:115], v4, s[16:19], s43 offen offset:0
    buffer_load_dwordx4 v[116:119], v4, s[16:19], s44 offen offset:0
    s_waitcnt vmcnt(12)
    v_mfma_f32_32x32x16_bf16 v[16:31], v[124:127], v[120:123], v[16:31]
    v_mfma_f32_32x32x16_bf16 v[32:47], v[128:131], v[120:123], v[32:47]
    v_mfma_f32_32x32x16_bf16 v[48:63], v[132:135], v[120:123], v[48:63]
    v_mfma_f32_32x32x16_bf16 v[64:79], v[136:139], v[120:123], v[64:79]
    v_mfma_f32_32x32x16_bf16 v[80:95], v[140:143], v[120:123], v[80:95]
    buffer_load_dwordx4 v[120:123], v4, s[16:19], s45 offen offset:1024
    buffer_load_dwordx4 v[124:127], v4, s[16:19], s40 offen offset:1024
    buffer_load_dwordx4 v[128:131], v4, s[16:19], s41 offen offset:1024
    buffer_load_dwordx4 v[132:135], v4, s[16:19], s42 offen offset:1024
    buffer_load_dwordx4 v[136:139], v4, s[16:19], s43 offen offset:1024
    buffer_load_dwordx4 v[140:143], v4, s[16:19], s44 offen offset:1024
    s_waitcnt vmcnt(12)
    v_mfma_f32_32x32x16_bf16 v[16:31], v[148:151], v[144:147], v[16:31]
    v_mfma_f32_32x32x16_bf16 v[32:47], v[152:155], v[144:147], v[32:47]
    v_mfma_f32_32x32x16_bf16 v[48:63], v[156:159], v[144:147], v[48:63]
    v_mfma_f32_32x32x16_bf16 v[64:79], v[160:163], v[144:147], v[64:79]
    v_mfma_f32_32x32x16_bf16 v[80:95], v[164:167], v[144:147], v[80:95]
    buffer_load_dwordx4 v[144:147], v4, s[16:19], s45 offen offset:2048
    buffer_load_dwordx4 v[148:151], v4, s[16:19], s40 offen offset:2048
    buffer_load_dwordx4 v[152:155], v4, s[16:19], s41 offen offset:2048
    buffer_load_dwordx4 v[156:159], v4, s[16:19], s42 offen offset:2048
    buffer_load_dwordx4 v[160:163], v4, s[16:19], s43 offen offset:2048
    buffer_load_dwordx4 v[164:167], v4, s[16:19], s44 offen offset:2048
    s_waitcnt vmcnt(12)
    v_mfma_f32_32x32x16_bf16 v[16:31], v[100:103], v[96:99], v[16:31]
    v_mfma_f32_32x32x16_bf16 v[32:47], v[104:107], v[96:99], v[32:47]
    v_mfma_f32_32x32x16_bf16 v[48:63], v[108:111], v[96:99], v[48:63]
    v_mfma_f32_32x32x16_bf16 v[64:79], v[112:115], v[96:99], v[64:79]
    v_mfma_f32_32x32x16_bf16 v[80:95], v[116:119], v[96:99], v[80:95]
    s_waitcnt vmcnt(6)
    v_mfma_f32_32x32x16_bf16 v[16:31], v[124:127], v[120:123], v[16:31]
    v_mfma_f32_32x32x16_bf16 v[32:47], v[128:131], v[120:123], v[32:47]
    v_mfma_f32_32x32x16_bf16 v[48:63], v[132:135], v[120:123], v[48:63]
    v_mfma_f32_32x32x16_bf16 v[64:79], v[136:139], v[120:123], v[64:79]
    v_mfma_f32_32x32x16_bf16 v[80:95], v[140:143], v[120:123], v[80:95]
    s_waitcnt vmcnt(0)
    v_mfma_f32_32x32x16_bf16 v[16:31], v[148:151], v[144:147], v[16:31]
    v_mfma_f32_32x32x16_bf16 v[32:47], v[152:155], v[144:147], v[32:47]
    v_mfma_f32_32x32x16_bf16 v[48:63], v[156:159], v[144:147], v[48:63]
    v_mfma_f32_32x32x16_bf16 v[64:79], v[160:163], v[144:147], v[64:79]
    v_mfma_f32_32x32x16_bf16 v[80:95], v[164:167], v[144:147], v[80:95]
    s_setprio 3
    s_lshl_b32 s46, s37, 2
    s_add_u32 s46, s46, s36
    s_mul_i32 s46, s46, 10240
    s_mul_i32 s48, s38, 2621440
    s_add_u32 s48, s48, s46
    s_add_u32 s48, s48, 50331648
    s_add_u32 s49, s48, 4096
    s_add_u32 s50, s48, 8192
    v_lshlrev_b32 v8, 3, v1
    s_nop 7
    v_cvt_pk_bf16_f32 v96, v16, v17
    v_cvt_pk_bf16_f32 v97, v18, v19
    buffer_store_dwordx2 v[96:97], v8, s[16:19], s48 offen offset:0 sc0 sc1
    v_cvt_pk_bf16_f32 v98, v20, v21
    v_cvt_pk_bf16_f32 v99, v22, v23
    buffer_store_dwordx2 v[98:99], v8, s[16:19], s48 offen offset:512 sc0 sc1
    v_cvt_pk_bf16_f32 v100, v24, v25
    v_cvt_pk_bf16_f32 v101, v26, v27
    buffer_store_dwordx2 v[100:101], v8, s[16:19], s48 offen offset:1024 sc0 sc1
    v_cvt_pk_bf16_f32 v102, v28, v29
    v_cvt_pk_bf16_f32 v103, v30, v31
    buffer_store_dwordx2 v[102:103], v8, s[16:19], s48 offen offset:1536 sc0 sc1
    v_cvt_pk_bf16_f32 v104, v32, v33
    v_cvt_pk_bf16_f32 v105, v34, v35
    buffer_store_dwordx2 v[104:105], v8, s[16:19], s48 offen offset:2048 sc0 sc1
    v_cvt_pk_bf16_f32 v106, v36, v37
    v_cvt_pk_bf16_f32 v107, v38, v39
    buffer_store_dwordx2 v[106:107], v8, s[16:19], s48 offen offset:2560 sc0 sc1
    v_cvt_pk_bf16_f32 v108, v40, v41
    v_cvt_pk_bf16_f32 v109, v42, v43
    buffer_store_dwordx2 v[108:109], v8, s[16:19], s48 offen offset:3072 sc0 sc1
    v_cvt_pk_bf16_f32 v110, v44, v45
    v_cvt_pk_bf16_f32 v111, v46, v47
    buffer_store_dwordx2 v[110:111], v8, s[16:19], s48 offen offset:3584 sc0 sc1
    v_cvt_pk_bf16_f32 v96, v48, v49
    v_cvt_pk_bf16_f32 v97, v50, v51
    buffer_store_dwordx2 v[96:97], v8, s[16:19], s49 offen offset:0 sc0 sc1
    v_cvt_pk_bf16_f32 v98, v52, v53
    v_cvt_pk_bf16_f32 v99, v54, v55
    buffer_store_dwordx2 v[98:99], v8, s[16:19], s49 offen offset:512 sc0 sc1
    v_cvt_pk_bf16_f32 v100, v56, v57
    v_cvt_pk_bf16_f32 v101, v58, v59
    buffer_store_dwordx2 v[100:101], v8, s[16:19], s49 offen offset:1024 sc0 sc1
    v_cvt_pk_bf16_f32 v102, v60, v61
    v_cvt_pk_bf16_f32 v103, v62, v63
    buffer_store_dwordx2 v[102:103], v8, s[16:19], s49 offen offset:1536 sc0 sc1
    v_cvt_pk_bf16_f32 v104, v64, v65
    v_cvt_pk_bf16_f32 v105, v66, v67
    buffer_store_dwordx2 v[104:105], v8, s[16:19], s49 offen offset:2048 sc0 sc1
    v_cvt_pk_bf16_f32 v106, v68, v69
    v_cvt_pk_bf16_f32 v107, v70, v71
    buffer_store_dwordx2 v[106:107], v8, s[16:19], s49 offen offset:2560 sc0 sc1
    v_cvt_pk_bf16_f32 v108, v72, v73
    v_cvt_pk_bf16_f32 v109, v74, v75
    buffer_store_dwordx2 v[108:109], v8, s[16:19], s49 offen offset:3072 sc0 sc1
    v_cvt_pk_bf16_f32 v110, v76, v77
    v_cvt_pk_bf16_f32 v111, v78, v79
    buffer_store_dwordx2 v[110:111], v8, s[16:19], s49 offen offset:3584 sc0 sc1
    v_cvt_pk_bf16_f32 v96, v80, v81
    v_cvt_pk_bf16_f32 v97, v82, v83
    buffer_store_dwordx2 v[96:97], v8, s[16:19], s50 offen offset:0 sc0 sc1
    v_cvt_pk_bf16_f32 v98, v84, v85
    v_cvt_pk_bf16_f32 v99, v86, v87
    buffer_store_dwordx2 v[98:99], v8, s[16:19], s50 offen offset:512 sc0 sc1
    v_cvt_pk_bf16_f32 v100, v88, v89
    v_cvt_pk_bf16_f32 v101, v90, v91
    buffer_store_dwordx2 v[100:101], v8, s[16:19], s50 offen offset:1024 sc0 sc1
    v_cvt_pk_bf16_f32 v102, v92, v93
    v_cvt_pk_bf16_f32 v103, v94, v95
    buffer_store_dwordx2 v[102:103], v8, s[16:19], s50 offen offset:1536 sc0 sc1
    s_waitcnt vmcnt(0)
    s_barrier
    s_setprio 3
    s_lshl_b32 s46, s37, 2
    s_add_u32 s46, s46, s36
    s_mul_i32 s46, s46, 10240
    s_mul_i32 s47, s38, 2560
    s_add_u32 s46, s46, s47
    s_add_u32 s48, s46, 50331648
    s_add_u32 s49, s46, 33554432
    buffer_load_dwordx2 v[16:17], v8, s[16:19], s48 offen offset:0
    buffer_load_dwordx2 v[18:19], v8, s[16:19], s48 offen offset:512
    buffer_load_dwordx2 v[20:21], v8, s[16:19], s48 offen offset:1024
    buffer_load_dwordx2 v[22:23], v8, s[16:19], s48 offen offset:1536
    buffer_load_dwordx2 v[24:25], v8, s[16:19], s48 offen offset:2048
    s_add_u32 s48, s48, 2621440
    buffer_load_dwordx2 v[26:27], v8, s[16:19], s48 offen offset:0
    buffer_load_dwordx2 v[28:29], v8, s[16:19], s48 offen offset:512
    buffer_load_dwordx2 v[30:31], v8, s[16:19], s48 offen offset:1024
    buffer_load_dwordx2 v[32:33], v8, s[16:19], s48 offen offset:1536
    buffer_load_dwordx2 v[34:35], v8, s[16:19], s48 offen offset:2048
    s_add_u32 s48, s48, 2621440
    buffer_load_dwordx2 v[36:37], v8, s[16:19], s48 offen offset:0
    buffer_load_dwordx2 v[38:39], v8, s[16:19], s48 offen offset:512
    buffer_load_dwordx2 v[40:41], v8, s[16:19], s48 offen offset:1024
    buffer_load_dwordx2 v[42:43], v8, s[16:19], s48 offen offset:1536
    buffer_load_dwordx2 v[44:45], v8, s[16:19], s48 offen offset:2048
    s_add_u32 s48, s48, 2621440
    buffer_load_dwordx2 v[46:47], v8, s[16:19], s48 offen offset:0
    buffer_load_dwordx2 v[48:49], v8, s[16:19], s48 offen offset:512
    buffer_load_dwordx2 v[50:51], v8, s[16:19], s48 offen offset:1024
    buffer_load_dwordx2 v[52:53], v8, s[16:19], s48 offen offset:1536
    buffer_load_dwordx2 v[54:55], v8, s[16:19], s48 offen offset:2048
    s_mov_b32 s52, 3216550459
    s_waitcnt vmcnt(0)
    v_lshlrev_b32 v64, 16, v16
    v_and_b32 v65, 0xffff0000, v16
    v_lshlrev_b32 v66, 16, v17
    v_and_b32 v67, 0xffff0000, v17
    v_lshlrev_b32 v68, 16, v26
    v_and_b32 v69, 0xffff0000, v26
    v_lshlrev_b32 v70, 16, v27
    v_and_b32 v71, 0xffff0000, v27
    v_lshlrev_b32 v72, 16, v36
    v_and_b32 v73, 0xffff0000, v36
    v_lshlrev_b32 v74, 16, v37
    v_and_b32 v75, 0xffff0000, v37
    v_lshlrev_b32 v76, 16, v46
    v_and_b32 v77, 0xffff0000, v46
    v_lshlrev_b32 v78, 16, v47
    v_and_b32 v79, 0xffff0000, v47
    v_pk_add_f32 v[64:65], v[64:65], v[68:69]
    v_pk_add_f32 v[72:73], v[72:73], v[76:77]
    v_pk_add_f32 v[66:67], v[66:67], v[70:71]
    v_pk_add_f32 v[74:75], v[74:75], v[78:79]
    v_pk_add_f32 v[64:65], v[64:65], v[72:73]
    v_pk_add_f32 v[66:67], v[66:67], v[74:75]
    v_cvt_pk_bf16_f32 v80, v64, v65
    v_cvt_pk_bf16_f32 v81, v66, v67
    buffer_store_dwordx2 v[80:81], v8, s[16:19], s49 offen offset:0 sc0 sc1
    v_lshlrev_b32 v84, 16, v18
    v_and_b32 v85, 0xffff0000, v18
    v_lshlrev_b32 v86, 16, v19
    v_and_b32 v87, 0xffff0000, v19
    v_lshlrev_b32 v88, 16, v28
    v_and_b32 v89, 0xffff0000, v28
    v_lshlrev_b32 v90, 16, v29
    v_and_b32 v91, 0xffff0000, v29
    v_lshlrev_b32 v92, 16, v38
    v_and_b32 v93, 0xffff0000, v38
    v_lshlrev_b32 v94, 16, v39
    v_and_b32 v95, 0xffff0000, v39
    v_lshlrev_b32 v96, 16, v48
    v_and_b32 v97, 0xffff0000, v48
    v_lshlrev_b32 v98, 16, v49
    v_and_b32 v99, 0xffff0000, v49
    v_pk_add_f32 v[84:85], v[84:85], v[88:89]
    v_pk_add_f32 v[92:93], v[92:93], v[96:97]
    v_pk_add_f32 v[86:87], v[86:87], v[90:91]
    v_pk_add_f32 v[94:95], v[94:95], v[98:99]
    v_pk_add_f32 v[84:85], v[84:85], v[92:93]
    v_pk_add_f32 v[86:87], v[86:87], v[94:95]
    v_cvt_pk_bf16_f32 v100, v84, v85
    v_cvt_pk_bf16_f32 v101, v86, v87
    buffer_store_dwordx2 v[100:101], v8, s[16:19], s49 offen offset:512 sc0 sc1
    v_lshlrev_b32 v64, 16, v20
    v_and_b32 v65, 0xffff0000, v20
    v_lshlrev_b32 v66, 16, v21
    v_and_b32 v67, 0xffff0000, v21
    v_lshlrev_b32 v68, 16, v30
    v_and_b32 v69, 0xffff0000, v30
    v_lshlrev_b32 v70, 16, v31
    v_and_b32 v71, 0xffff0000, v31
    v_lshlrev_b32 v72, 16, v40
    v_and_b32 v73, 0xffff0000, v40
    v_lshlrev_b32 v74, 16, v41
    v_and_b32 v75, 0xffff0000, v41
    v_lshlrev_b32 v76, 16, v50
    v_and_b32 v77, 0xffff0000, v50
    v_lshlrev_b32 v78, 16, v51
    v_and_b32 v79, 0xffff0000, v51
    v_pk_add_f32 v[64:65], v[64:65], v[68:69]
    v_pk_add_f32 v[72:73], v[72:73], v[76:77]
    v_pk_add_f32 v[66:67], v[66:67], v[70:71]
    v_pk_add_f32 v[74:75], v[74:75], v[78:79]
    v_pk_add_f32 v[64:65], v[64:65], v[72:73]
    v_pk_add_f32 v[66:67], v[66:67], v[74:75]
    v_cvt_pk_bf16_f32 v80, v64, v65
    v_cvt_pk_bf16_f32 v81, v66, v67
    buffer_store_dwordx2 v[80:81], v8, s[16:19], s49 offen offset:1024 sc0 sc1
    v_lshlrev_b32 v84, 16, v22
    v_and_b32 v85, 0xffff0000, v22
    v_lshlrev_b32 v86, 16, v23
    v_and_b32 v87, 0xffff0000, v23
    v_lshlrev_b32 v88, 16, v32
    v_and_b32 v89, 0xffff0000, v32
    v_lshlrev_b32 v90, 16, v33
    v_and_b32 v91, 0xffff0000, v33
    v_lshlrev_b32 v92, 16, v42
    v_and_b32 v93, 0xffff0000, v42
    v_lshlrev_b32 v94, 16, v43
    v_and_b32 v95, 0xffff0000, v43
    v_lshlrev_b32 v96, 16, v52
    v_and_b32 v97, 0xffff0000, v52
    v_lshlrev_b32 v98, 16, v53
    v_and_b32 v99, 0xffff0000, v53
    v_pk_add_f32 v[84:85], v[84:85], v[88:89]
    v_pk_add_f32 v[92:93], v[92:93], v[96:97]
    v_pk_add_f32 v[86:87], v[86:87], v[90:91]
    v_pk_add_f32 v[94:95], v[94:95], v[98:99]
    v_pk_add_f32 v[84:85], v[84:85], v[92:93]
    v_pk_add_f32 v[86:87], v[86:87], v[94:95]
    v_cvt_pk_bf16_f32 v100, v84, v85
    v_cvt_pk_bf16_f32 v101, v86, v87
    buffer_store_dwordx2 v[100:101], v8, s[16:19], s49 offen offset:1536 sc0 sc1
    v_lshlrev_b32 v64, 16, v24
    v_and_b32 v65, 0xffff0000, v24
    v_lshlrev_b32 v66, 16, v25
    v_and_b32 v67, 0xffff0000, v25
    v_lshlrev_b32 v68, 16, v34
    v_and_b32 v69, 0xffff0000, v34
    v_lshlrev_b32 v70, 16, v35
    v_and_b32 v71, 0xffff0000, v35
    v_lshlrev_b32 v72, 16, v44
    v_and_b32 v73, 0xffff0000, v44
    v_lshlrev_b32 v74, 16, v45
    v_and_b32 v75, 0xffff0000, v45
    v_lshlrev_b32 v76, 16, v54
    v_and_b32 v77, 0xffff0000, v54
    v_lshlrev_b32 v78, 16, v55
    v_and_b32 v79, 0xffff0000, v55
    v_pk_add_f32 v[64:65], v[64:65], v[68:69]
    v_pk_add_f32 v[72:73], v[72:73], v[76:77]
    v_pk_add_f32 v[66:67], v[66:67], v[70:71]
    v_pk_add_f32 v[74:75], v[74:75], v[78:79]
    v_pk_add_f32 v[64:65], v[64:65], v[72:73]
    v_pk_add_f32 v[66:67], v[66:67], v[74:75]
    v_cvt_pk_bf16_f32 v80, v64, v65
    v_cvt_pk_bf16_f32 v81, v66, v67
    buffer_store_dwordx2 v[80:81], v8, s[16:19], s49 offen offset:2048 sc0 sc1
    s_lshr_b32 s46, s2, 3
    s_lshl_b32 s46, s46, 2
    s_add_u32 s46, s46, s38
    s_min_u32 s46, s46, 99
    s_lshl_b32 s46, s46, 13
    s_add_u32 s46, s46, 25165824
    v_lshlrev_b32 v9, 7, v1
    buffer_load_dword v10, v9, s[16:19], s46 offen
    s_mov_b32 s12, s6
    s_mov_b32 s13, s7
    s_mov_b32 s14, 2621440
    s_mov_b32 s15, 0x00020000
    s_lshl_b32 s46, s37, 5
    s_lshl_b32 s47, s38, 3
    s_add_u32 s46, s46, s47
    s_mul_i32 s46, s46, 1280
    s_mul_i32 s47, s36, 320
    s_add_u32 s46, s46, s47
    s_and_b32 s46, s46, 0xffffff80
    v_lshrrev_b32 v9, 3, v1
    v_mul_u32_u24 v9, 1280, v9
    v_and_b32 v11, 3, v1
    v_lshl_add_u32 v9, v11, 7, v9
    buffer_load_dword v11, v9, s[12:15], s46 offen
    s_setprio 0
    s_add_u32 s38, s38, 8
    s_barrier
    s_barrier
    s_barrier
K2_FIN:
K2_END:
    s_endpgm
.globl k3_kernel
.p2align 8
.type k3_kernel,@function
k3_kernel:
    s_cmp_ge_u32 s2, 256
    s_cbranch_scc1 K3_END
    s_load_dwordx2 s[24:25], s[0:1], 80
    s_load_dwordx2 s[4:5], s[0:1], 0
    s_load_dwordx2 s[6:7], s[0:1], 64
    s_load_dwordx2 s[26:27], s[0:1], 56
    v_and_b32 v1, 63, v0
    v_lshrrev_b32 v2, 6, v0
    s_and_b32 s3, s2, 7
    s_lshr_b32 s36, s2, 3
    v_readfirstlane_b32 s38, v2
    s_lshl_b32 s3, s3, 3
    s_lshr_b32 s37, s36, 2
    s_add_u32 s37, s37, s3
    s_and_b32 s36, s36, 3
    v_and_b32 v2, 31, v1
    v_lshrrev_b32 v3, 5, v1
    v_lshlrev_b32 v4, 4, v1
    v_lshlrev_b32 v5, 3, v1
    s_cmp_ge_u32 s38, 5
    s_cselect_b32 s41, 1, 0
    s_cselect_b32 s42, 5, 0
    s_sub_u32 s42, s38, s42
    s_mul_i32 s46, s36, 5
    s_add_u32 s46, s46, s42
    s_mul_i32 s40, s46, 40960
    s_mul_i32 s46, s41, 20480
    s_add_u32 s40, s40, s46
    s_add_u32 s40, s40, 25165824
    v_add_u32 v6, s46, v4
    s_mul_i32 s45, s37, 40
    s_lshl_b32 s46, s38, 2
    s_add_u32 s45, s45, s46
    s_lshl_b32 s45, s45, 10
    s_add_u32 s45, s45, 29360128
    s_lshl_b32 s44, s38, 12
    v_mul_u32_u24 v11, 3277, v0
    v_lshrrev_b32 v11, 16, v11
    v_mul_u32_u24 v12, 20, v11
    v_sub_u32 v12, v0, v12
    s_lshl_b32 s47, s37, 5
    s_mul_i32 s46, s36, 320
    s_mul_i32 s47, s47, 1280
    s_add_u32 s53, s46, s47
    v_mul_u32_u24 v8, 1280, v11
    v_lshl_add_u32 v8, v12, 4, v8
    v_mul_u32_u24 v11, 336, v11
    v_lshl_add_u32 v11, v12, 4, v11
    v_add_u32 v11, 40960, v11
    s_lshl_b32 s46, s37, 2
    s_add_u32 s46, s46, s36
    s_mul_i32 s46, s46, 10240
    s_lshl_b32 s47, s42, 11
    s_add_u32 s46, s46, s47
    s_lshl_b32 s47, s41, 10
    s_add_u32 s46, s46, s47
    s_add_u32 s48, s46, 33554432
    s_mul_i32 s46, s36, 160
    s_lshl_b32 s47, s42, 5
    s_add_u32 s46, s46, s47
    s_lshl_b32 s47, s41, 4
    s_add_u32 s46, s46, s47
    v_lshl_add_u32 v7, v3, 2, s46
    v_lshlrev_b32 v7, 1, v7
    v_mul_u32_u24 v13, 336, v2
    v_lshl_add_u32 v13, v3, 3, v13
    s_lshl_b32 s46, s42, 6
    s_lshl_b32 s47, s41, 5
    s_add_u32 s46, s46, s47
    s_add_u32 s46, s46, 40960
    v_add_u32 v13, s46, v13
    s_lshl_b32 s46, s42, 1
    s_add_u32 s47, s46, s41
    s_lshl_b32 s47, s47, 11
    s_add_u32 s47, s47, 53248
    v_add_u32 v14, s47, v4
    s_xor_b32 s47, s41, 1
    s_add_u32 s47, s46, s47
    s_lshl_b32 s47, s47, 11
    s_add_u32 s47, s47, 53248
    v_add_u32 v15, s47, v4
    s_mov_b32 s52, 3216550459
    s_waitcnt lgkmcnt(0)
    s_mov_b32 s16, s24
    s_mov_b32 s17, s25
    s_mov_b32 s18, 75497472
    s_mov_b32 s19, 0x00020000
    s_mov_b32 m0, s44
    s_nop 0
    buffer_load_dwordx4 v4, s[16:19], s45 offen offset:0 lds
    buffer_load_dwordx4 v4, s[16:19], s45 offen offset:1024 lds
    buffer_load_dwordx4 v4, s[16:19], s45 offen offset:2048 lds
    buffer_load_dwordx4 v4, s[16:19], s45 offen offset:3072 lds
    s_mov_b32 s8, s4
    s_mov_b32 s9, s5
    s_mov_b32 s10, 2621440
    s_mov_b32 s11, 0x00020000
    s_mov_b32 s12, s6
    s_mov_b32 s13, s7
    s_mov_b32 s14, 2621440
    s_mov_b32 s15, 0x00020000
    s_mov_b32 s20, s26
    s_mov_b32 s21, s27
    s_mov_b32 s22, 1280
    s_mov_b32 s23, 0x00020000
    buffer_load_dwordx2 v[128:129], v5, s[16:19], s48 offen offset:0
    buffer_load_dwordx2 v[130:131], v7, s[20:23], 0 offen offset:0
    buffer_load_dwordx2 v[132:133], v5, s[16:19], s48 offen offset:512
    buffer_load_dwordx2 v[134:135], v7, s[20:23], 0 offen offset:16
    buffer_load_dwordx4 v[16:19], v4, s[16:19], s40 offen offset:0
    buffer_load_dwordx4 v[20:23], v4, s[16:19], s40 offen offset:1024
    buffer_load_dwordx4 v[24:27], v4, s[16:19], s40 offen offset:2048
    buffer_load_dwordx4 v[28:31], v4, s[16:19], s40 offen offset:3072
    s_add_u32 s40, s40, 4096
    buffer_load_dwordx4 v[32:35], v4, s[16:19], s40 offen offset:0
    buffer_load_dwordx4 v[36:39], v4, s[16:19], s40 offen offset:1024
    buffer_load_dwordx4 v[40:43], v4, s[16:19], s40 offen offset:2048
    buffer_load_dwordx4 v[44:47], v4, s[16:19], s40 offen offset:3072
    s_add_u32 s40, s40, 4096
    s_waitcnt vmcnt(8)
    s_barrier
    ds_read_b128 v[112:115], v6 offset:0
    ds_read_b128 v[116:119], v6 offset:1024
    ds_read_b128 v[120:123], v6 offset:2048
    buffer_load_dwordx4 v[48:51], v4, s[16:19], s40 offen offset:0
    ds_read_b128 v[124:127], v6 offset:3072
    s_waitcnt vmcnt(8) lgkmcnt(3)
    v_mfma_f32_32x32x16_bf16 v[96:111], v[16:19], v[112:115], 0
    v_lshlrev_b32 v148, 16, v128
    v_and_b32 v149, 0xffff0000, v128
    v_lshlrev_b32 v150, 16, v129
    v_and_b32 v151, 0xffff0000, v129
    v_lshlrev_b32 v152, 16, v130
    v_and_b32 v153, 0xffff0000, v130
    buffer_load_dwordx4 v[52:55], v4, s[16:19], s40 offen offset:1024
    ds_read_b128 v[112:115], v6 offset:4096
    s_waitcnt vmcnt(8) lgkmcnt(3)
    v_mfma_f32_32x32x16_bf16 v[96:111], v[20:23], v[116:119], v[96:111]
    v_lshlrev_b32 v154, 16, v131
    v_and_b32 v155, 0xffff0000, v131
    v_add_f32 v148, v148, v152
    v_add_f32 v149, v149, v153
    v_add_f32 v150, v150, v154
    v_add_f32 v151, v151, v155
    buffer_load_dwordx4 v[56:59], v4, s[16:19], s40 offen offset:2048
    ds_read_b128 v[116:119], v6 offset:5120
    s_waitcnt vmcnt(8) lgkmcnt(3)
    v_mfma_f32_32x32x16_bf16 v[96:111], v[24:27], v[120:123], v[96:111]
    v_cvt_pk_bf16_f32 v152, v148, v149
    v_cvt_pk_bf16_f32 v153, v150, v151
    v_lshlrev_b32 v148, 16, v152
    v_and_b32 v149, 0xffff0000, v152
    v_lshlrev_b32 v150, 16, v153
    v_and_b32 v151, 0xffff0000, v153
    buffer_load_dwordx4 v[60:63], v4, s[16:19], s40 offen offset:3072
    s_add_u32 s40, s40, 4096
    ds_read_b128 v[120:123], v6 offset:6144
    s_waitcnt vmcnt(8) lgkmcnt(3)
    v_mfma_f32_32x32x16_bf16 v[96:111], v[28:31], v[124:127], v[96:111]
    v_mul_f32 v136, s52, v148
    v_mul_f32 v137, s52, v149
    v_mul_f32 v138, s52, v150
    v_mul_f32 v139, s52, v151
    v_exp_f32 v136, v136
    v_exp_f32 v137, v137
    buffer_load_dwordx4 v[64:67], v4, s[16:19], s40 offen offset:0
    ds_read_b128 v[124:127], v6 offset:7168
    s_waitcnt vmcnt(8) lgkmcnt(3)
    v_mfma_f32_32x32x16_bf16 v[96:111], v[32:35], v[112:115], v[96:111]
    v_exp_f32 v138, v138
    v_exp_f32 v139, v139
    s_nop 0
    v_add_f32 v136, 1.0, v136
    v_add_f32 v137, 1.0, v137
    v_add_f32 v138, 1.0, v138
    buffer_load_dwordx4 v[68:71], v4, s[16:19], s40 offen offset:1024
    ds_read_b128 v[112:115], v6 offset:8192
    s_waitcnt vmcnt(8) lgkmcnt(3)
    v_mfma_f32_32x32x16_bf16 v[96:111], v[36:39], v[116:119], v[96:111]
    v_add_f32 v139, 1.0, v139
    v_rcp_f32 v136, v136
    v_rcp_f32 v137, v137
    v_rcp_f32 v138, v138
    v_rcp_f32 v139, v139
    s_nop 0
    buffer_load_dwordx4 v[72:75], v4, s[16:19], s40 offen offset:2048
    ds_read_b128 v[116:119], v6 offset:9216
    s_waitcnt vmcnt(8) lgkmcnt(3)
    v_mfma_f32_32x32x16_bf16 v[96:111], v[40:43], v[120:123], v[96:111]
    v_mul_f32 v136, v136, v148
    v_mul_f32 v137, v137, v149
    v_mul_f32 v138, v138, v150
    v_mul_f32 v139, v139, v151
    v_cvt_pk_bf16_f32 v152, v136, v137
    v_cvt_pk_bf16_f32 v153, v138, v139
    buffer_load_dwordx4 v[76:79], v4, s[16:19], s40 offen offset:3072
    s_add_u32 s40, s40, 4096
    ds_read_b128 v[120:123], v6 offset:10240
    s_waitcnt vmcnt(8) lgkmcnt(3)
    v_mfma_f32_32x32x16_bf16 v[96:111], v[44:47], v[124:127], v[96:111]
    v_lshlrev_b32 v136, 16, v152
    v_and_b32 v137, 0xffff0000, v152
    v_lshlrev_b32 v138, 16, v153
    v_and_b32 v139, 0xffff0000, v153
    v_lshlrev_b32 v148, 16, v132
    v_and_b32 v149, 0xffff0000, v132
    buffer_load_dwordx4 v[80:83], v4, s[16:19], s40 offen offset:0
    ds_read_b128 v[124:127], v6 offset:11264
    s_waitcnt vmcnt(8) lgkmcnt(3)
    v_mfma_f32_32x32x16_bf16 v[96:111], v[48:51], v[112:115], v[96:111]
    v_lshlrev_b32 v150, 16, v133
    v_and_b32 v151, 0xffff0000, v133
    v_lshlrev_b32 v152, 16, v134
    v_and_b32 v153, 0xffff0000, v134
    v_lshlrev_b32 v154, 16, v135
    v_and_b32 v155, 0xffff0000, v135
    buffer_load_dwordx4 v[84:87], v4, s[16:19], s40 offen offset:1024
    ds_read_b128 v[112:115], v6 offset:12288
    s_waitcnt vmcnt(8) lgkmcnt(3)
    v_mfma_f32_32x32x16_bf16 v[96:111], v[52:55], v[116:119], v[96:111]
    v_add_f32 v148, v148, v152
    v_add_f32 v149, v149, v153
    v_add_f32 v150, v150, v154
    v_add_f32 v151, v151, v155
    v_cvt_pk_bf16_f32 v152, v148, v149
    v_cvt_pk_bf16_f32 v153, v150, v151
    buffer_load_dwordx4 v[88:91], v4, s[16:19], s40 offen offset:2048
    ds_read_b128 v[116:119], v6 offset:13312
    s_waitcnt vmcnt(8) lgkmcnt(3)
    v_mfma_f32_32x32x16_bf16 v[96:111], v[56:59], v[120:123], v[96:111]
    v_lshlrev_b32 v148, 16, v152
    v_and_b32 v149, 0xffff0000, v152
    v_lshlrev_b32 v150, 16, v153
    v_and_b32 v151, 0xffff0000, v153
    v_mul_f32 v140, s52, v148
    v_mul_f32 v141, s52, v149
    buffer_load_dwordx4 v[92:95], v4, s[16:19], s40 offen offset:3072
    s_add_u32 s40, s40, 4096
    ds_read_b128 v[120:123], v6 offset:14336
    s_waitcnt vmcnt(8) lgkmcnt(3)
    v_mfma_f32_32x32x16_bf16 v[96:111], v[60:63], v[124:127], v[96:111]
    v_mul_f32 v142, s52, v150
    v_mul_f32 v143, s52, v151
    v_exp_f32 v140, v140
    v_exp_f32 v141, v141
    v_exp_f32 v142, v142
    v_exp_f32 v143, v143
    buffer_load_dwordx4 v[144:147], v8, s[8:11], s53 offen
    ds_read_b128 v[124:127], v6 offset:15360
    s_waitcnt vmcnt(8) lgkmcnt(3)
    v_mfma_f32_32x32x16_bf16 v[96:111], v[64:67], v[112:115], v[96:111]
    s_nop 0
    v_add_f32 v140, 1.0, v140
    v_add_f32 v141, 1.0, v141
    v_add_f32 v142, 1.0, v142
    v_add_f32 v143, 1.0, v143
    v_rcp_f32 v140, v140
    ds_read_b128 v[112:115], v6 offset:16384
    s_waitcnt vmcnt(7) lgkmcnt(3)
    v_mfma_f32_32x32x16_bf16 v[96:111], v[68:71], v[116:119], v[96:111]
    v_rcp_f32 v141, v141
    v_rcp_f32 v142, v142
    v_rcp_f32 v143, v143
    s_nop 0
    v_mul_f32 v140, v140, v148
    v_mul_f32 v141, v141, v149
    ds_read_b128 v[116:119], v6 offset:17408
    s_waitcnt vmcnt(6) lgkmcnt(3)
    v_mfma_f32_32x32x16_bf16 v[96:111], v[72:75], v[120:123], v[96:111]
    v_mul_f32 v142, v142, v150
    v_mul_f32 v143, v143, v151
    v_cvt_pk_bf16_f32 v152, v140, v141
    v_cvt_pk_bf16_f32 v153, v142, v143
    v_lshlrev_b32 v140, 16, v152
    v_and_b32 v141, 0xffff0000, v152
    ds_read_b128 v[120:123], v6 offset:18432
    s_waitcnt vmcnt(5) lgkmcnt(3)
    v_mfma_f32_32x32x16_bf16 v[96:111], v[76:79], v[124:127], v[96:111]
    v_lshlrev_b32 v142, 16, v153
    v_and_b32 v143, 0xffff0000, v153
    ds_read_b128 v[124:127], v6 offset:19456
    s_waitcnt vmcnt(4) lgkmcnt(3)
    v_mfma_f32_32x32x16_bf16 v[96:111], v[80:83], v[112:115], v[96:111]
    s_waitcnt vmcnt(3) lgkmcnt(2)
    v_mfma_f32_32x32x16_bf16 v[96:111], v[84:87], v[116:119], v[96:111]
    s_waitcnt vmcnt(2) lgkmcnt(1)
    v_mfma_f32_32x32x16_bf16 v[96:111], v[88:91], v[120:123], v[96:111]
    s_waitcnt vmcnt(1) lgkmcnt(0)
    v_mfma_f32_32x32x16_bf16 v[96:111], v[92:95], v[124:127], v[96:111]
    s_nop 13
    s_cmp_eq_u32 s41, 0
    s_cbranch_scc1 K3_X0
    ds_write_b128 v14, v[96:99]
    ds_write_b128 v14, v[100:103] offset:1024
    v_mov_b32 v16, v104
    v_mov_b32 v17, v105
    v_mov_b32 v18, v106
    v_mov_b32 v19, v107
    v_mov_b32 v20, v108
    v_mov_b32 v21, v109
    v_mov_b32 v22, v110
    v_mov_b32 v23, v111
    s_branch K3_X1
K3_X0:
    ds_write_b128 v14, v[104:107]
    ds_write_b128 v14, v[108:111] offset:1024
    v_mov_b32 v16, v96
    v_mov_b32 v17, v97
    v_mov_b32 v18, v98
    v_mov_b32 v19, v99
    v_mov_b32 v20, v100
    v_mov_b32 v21, v101
    v_mov_b32 v22, v102
    v_mov_b32 v23, v103
K3_X1:
    s_waitcnt lgkmcnt(0)
    s_barrier
    ds_read_b128 v[24:27], v15
    ds_read_b128 v[28:31], v15 offset:1024
    s_waitcnt lgkmcnt(0)
    v_pk_add_f32 v[16:17], v[16:17], v[24:25]
    v_pk_add_f32 v[18:19], v[18:19], v[26:27]
    v_pk_add_f32 v[20:21], v[20:21], v[28:29]
    v_pk_add_f32 v[22:23], v[22:23], v[30:31]
    v_cvt_pk_bf16_f32 v32, v16, v17
    v_cvt_pk_bf16_f32 v33, v18, v19
    v_lshlrev_b32 v16, 16, v32
    v_and_b32 v17, 0xffff0000, v32
    v_lshlrev_b32 v18, 16, v33
    v_and_b32 v19, 0xffff0000, v33
    v_pk_mul_f32 v[16:17], v[16:17], v[136:137]
    v_pk_mul_f32 v[18:19], v[18:19], v[138:139]
    v_cvt_pk_bf16_f32 v34, v16, v17
    v_cvt_pk_bf16_f32 v35, v18, v19
    ds_write_b64 v13, v[34:35] offset:0
    v_cvt_pk_bf16_f32 v36, v20, v21
    v_cvt_pk_bf16_f32 v37, v22, v23
    v_lshlrev_b32 v20, 16, v36
    v_and_b32 v21, 0xffff0000, v36
    v_lshlrev_b32 v22, 16, v37
    v_and_b32 v23, 0xffff0000, v37
    v_pk_mul_f32 v[20:21], v[20:21], v[140:141]
    v_pk_mul_f32 v[22:23], v[22:23], v[142:143]
    v_cvt_pk_bf16_f32 v38, v20, v21
    v_cvt_pk_bf16_f32 v39, v22, v23
    ds_write_b64 v13, v[38:39] offset:16
    s_waitcnt lgkmcnt(0)
    s_barrier
    ds_read_b128 v[40:43], v11
    s_waitcnt vmcnt(0) lgkmcnt(0)
    v_lshlrev_b32 v48, 16, v40
    v_and_b32 v49, 0xffff0000, v40
    v_lshlrev_b32 v50, 16, v144
    v_and_b32 v51, 0xffff0000, v144
    v_pk_add_f32 v[48:49], v[48:49], v[50:51]
    v_cvt_pk_bf16_f32 v40, v48, v49
    v_lshlrev_b32 v52, 16, v41
    v_and_b32 v53, 0xffff0000, v41
    v_lshlrev_b32 v54, 16, v145
    v_and_b32 v55, 0xffff0000, v145
    v_pk_add_f32 v[52:53], v[52:53], v[54:55]
    v_cvt_pk_bf16_f32 v41, v52, v53
    v_lshlrev_b32 v56, 16, v42
    v_and_b32 v57, 0xffff0000, v42
    v_lshlrev_b32 v58, 16, v146
    v_and_b32 v59, 0xffff0000, v146
    v_pk_add_f32 v[56:57], v[56:57], v[58:59]
    v_cvt_pk_bf16_f32 v42, v56, v57
    v_lshlrev_b32 v60, 16, v43
    v_and_b32 v61, 0xffff0000, v43
    v_lshlrev_b32 v62, 16, v147
    v_and_b32 v63, 0xffff0000, v147
    v_pk_add_f32 v[60:61], v[60:61], v[62:63]
    v_cvt_pk_bf16_f32 v43, v60, v61
    buffer_store_dwordx4 v[40:43], v8, s[12:15], s53 offen sc0 sc1
K3_END:
    s_endpgm
CODE_END:
    s_endpgm
.section .rodata,"a"
.p2align 6
.amdhsa_kernel k1_kernel
  .amdhsa_next_free_vgpr 256
  .amdhsa_next_free_sgpr 102
  .amdhsa_accum_offset 256
  .amdhsa_group_segment_fixed_size 0
  .amdhsa_kernarg_size 88
  .amdhsa_user_sgpr_count 2
  .amdhsa_user_sgpr_kernarg_segment_ptr 1
  .amdhsa_system_sgpr_workgroup_id_x 1
  .amdhsa_float_denorm_mode_32 3
.end_amdhsa_kernel
.p2align 6
.amdhsa_kernel k2_kernel
  .amdhsa_next_free_vgpr 168
  .amdhsa_next_free_sgpr 102
  .amdhsa_accum_offset 168
  .amdhsa_group_segment_fixed_size 0
  .amdhsa_kernarg_size 88
  .amdhsa_user_sgpr_count 2
  .amdhsa_user_sgpr_kernarg_segment_ptr 1
  .amdhsa_system_sgpr_workgroup_id_x 1
  .amdhsa_float_denorm_mode_32 3
.end_amdhsa_kernel
.p2align 6
.amdhsa_kernel k3_kernel
  .amdhsa_next_free_vgpr 168
  .amdhsa_next_free_sgpr 102
  .amdhsa_accum_offset 168
  .amdhsa_group_segment_fixed_size 0
  .amdhsa_kernarg_size 88
  .amdhsa_user_sgpr_count 2
  .amdhsa_user_sgpr_kernarg_segment_ptr 1
  .amdhsa_system_sgpr_workgroup_id_x 1
  .amdhsa_float_denorm_mode_32 3
.end_amdhsa_kernel
```
